```python
import torch

def _softmax(x, axis=-1):
    return torch.softmax(x, dim=axis)
def _gelu(x):
    return torch.nn.functional.gelu(x, approximate="tanh")
def _silu(x):
    return torch.nn.functional.silu(x)
def _sigmoid(x):
    return torch.sigmoid(x)
def _layernorm(x, axis=-1, eps=1e-5):
    m = x.mean(dim=axis, keepdim=True)
    v = x.var(dim=axis, keepdim=True, unbiased=False)
    return (x - m) / torch.sqrt(v + eps)
def _scatter_add(tgt, idx, src, axis=0):
    return tgt.clone().index_add_(axis, idx, src)
def _segment_sum(src, seg, n):
    out = torch.zeros((n,) + src.shape[1:], dtype=src.dtype)
    return out.index_add_(0, seg, src)
def _pad(x, pw):
    flat = tuple(v for pair in reversed(pw) for v in pair)
    return torch.nn.functional.pad(x, flat)

kernel_name = 'standalone__mixer_channel_mlp__prompt'

def setup_inputs():

    _w = (lambda a: (lambda t: t.to(torch.bfloat16) if t.is_floating_point() else t)(torch.as_tensor(a)))
    B, S, D, F = 1, 2048, 576, 4608
    return {
        "x": _w((lambda *s: torch.randn(*s, dtype=torch.bfloat16) * 0.05)(B, S, D)),
        "w1": _w((lambda *s: torch.randn(*s, dtype=torch.bfloat16) * 0.8)(D, F) * (D ** -0.5)),
        "b1": _w((lambda *s: torch.randn(*s, dtype=torch.bfloat16) * 0.4)(F)),
        "w2": _w((lambda *s: torch.randn(*s, dtype=torch.bfloat16) * 0.05)(F, D) * (F ** -0.5)),
        "b2": _w((lambda *s: torch.randn(*s, dtype=torch.bfloat16) * 0.05)(D)),
    }

def reference(x, w1, b1, w2, b2):
    y = _layernorm(x, axis=-1)
    h = _gelu(torch.einsum("bsd,df->bsf", y, w1) + b1)
    return torch.einsum("bsf,fd->bsd", h, w2) + b2
```

```asm
; @launch grid=(256,1,1) block=(512,1,1) lds=163840
.amdgcn_target "amdgcn-amd-amdhsa--gfx950"
.text
.globl standalone__mixer_channel_mlp__prompt_kernel
.p2align 8
.type standalone__mixer_channel_mlp__prompt_kernel,@function
standalone__mixer_channel_mlp__prompt_kernel:
s_cmp_ge_u32 s2, 256
s_cbranch_scc1 standalone__mixer_channel_mlp__prompt_kernel_end
s_load_dwordx16 s[44:59], s[0:1], 0
s_and_b32 s27, s2, 7
s_lshr_b32 s28, s2, 3
s_and_b32 s25, s27, 3
s_mul_i32 s25, s25, 2
s_and_b32 s29, s28, 1
s_add_u32 s25, s25, s29
s_lshr_b32 s26, s27, 2
s_mul_i32 s26, s26, 16
s_lshr_b32 s29, s28, 1
s_add_u32 s26, s26, s29
v_lshrrev_b32 v20, 6, v0
v_and_b32 v1, 63, v0
v_and_b32 v25, 7, v0
v_lshrrev_b32 v26, 3, v1
v_readfirstlane_b32 s24, v20
s_lshl_b32 s30, s26, 6
v_lshl_add_u32 v27, v20, 3, v26
v_add_u32 v28, s30, v27
v_mul_u32_u24 v28, 1152, v28
v_lshl_add_u32 v28, v25, 4, v28
s_mov_b32 s3, 0
s_mov_b32 s32, 0
s_lshl_b32 s60, s3, 7
s_add_u32 s61, s60, 128
s_cmp_eq_u32 s61, 1152
s_cselect_b32 s61, 0, s61
s_add_u32 s62, s61, 128
s_cmp_eq_u32 s62, 1152
s_cselect_b32 s62, 0, s62
s_add_u32 s63, s62, 128
s_cmp_eq_u32 s63, 1152
s_cselect_b32 s63, 0, s63
s_add_u32 s64, s63, 128
s_cmp_eq_u32 s64, 1152
s_cselect_b32 s64, 0, s64
s_add_u32 s65, s64, 128
s_cmp_eq_u32 s65, 1152
s_cselect_b32 s65, 0, s65
s_add_u32 s66, s65, 128
s_cmp_eq_u32 s66, 1152
s_cselect_b32 s66, 0, s66
s_add_u32 s67, s66, 128
s_cmp_eq_u32 s67, 1152
s_cselect_b32 s67, 0, s67
s_add_u32 s68, s67, 128
s_cmp_eq_u32 s68, 1152
s_cselect_b32 s68, 0, s68
s_mov_b32 s6, 2359296
s_mov_b32 s7, 0x20000
s_mov_b32 s10, 5308416
s_mov_b32 s11, 0x20000
s_mul_i32 s31, s25, 1152
s_mul_i32 s33, s25, 576
s_lshl_b32 s34, s24, 10
v_lshl_add_u32 v29, v20, 3, v26
v_and_b32 v30, 2, v26
v_and_b32 v31, 1, v20
v_lshl_or_b32 v30, v31, 2, v30
v_xor_b32 v30, v30, v25
v_mul_u32_u24 v8, 9216, v29
v_lshl_add_u32 v8, v30, 4, v8
v_add_u32 v8, s31, v8
s_lshl_b32 s78, s32, 7
s_lshl_b32 s79, s32, 8
s_mul_i32 s36, s29, 36
v_cvt_f32_u32 v30, v0
v_add_f32 v30, 0.5, v30
v_mul_f32 v30, 0x3ce38e39, v30
v_cvt_u32_f32 v30, v30
v_mul_u32_u24 v31, 36, v30
v_sub_u32 v31, v0, v31
v_add_u32 v31, s36, v31
v_lshlrev_b32 v30, 7, v30
v_min_u32 v30, 1024, v30
v_mul_u32_u24 v45, 9216, v31
v_add3_u32 v45, v45, v30, s31
v_add_u32 v31, s33, v31
v_mul_u32_u24 v46, 1152, v31
v_add_u32 v46, v46, v30
v_mul_u32_u24 v47, 112, v25
v_add_u32 v47, v47, v28
s_waitcnt lgkmcnt(0)
s_mov_b32 s4, s44
s_mov_b32 s5, s45
s_mov_b32 s8, s46
s_mov_b32 s9, s47
buffer_load_dwordx4 v[60:63], v28, s[4:7], s60 offen
buffer_load_dwordx4 v[64:67], v28, s[4:7], s61 offen
buffer_load_dwordx4 v[68:71], v28, s[4:7], s62 offen
buffer_load_dwordx4 v[84:87], v28, s[4:7], s63 offen
buffer_load_dwordx4 v[88:91], v28, s[4:7], s64 offen
buffer_load_dwordx4 v[92:95], v28, s[4:7], s65 offen
buffer_load_dwordx4 v[96:99], v28, s[4:7], s66 offen
buffer_load_dwordx4 v[100:103], v28, s[4:7], s67 offen
buffer_load_dwordx4 v[104:107], v28, s[4:7], s68 offen
s_mul_i32 s60, s60, 4608
s_mul_i32 s61, s61, 4608
s_mul_i32 s62, s62, 4608
s_mul_i32 s63, s63, 4608
s_mul_i32 s64, s64, 4608
s_mul_i32 s65, s65, 4608
s_mul_i32 s66, s66, 4608
s_mul_i32 s67, s67, 4608
s_mul_i32 s68, s68, 4608
s_add_u32 s20, s48, s31
s_addc_u32 s21, s49, 0
s_mov_b32 s22, 1152
s_mov_b32 s23, 0x20000
v_lshlrev_b32 v30, 3, v0
buffer_load_dwordx2 v[36:37], v30, s[20:23], 0 offen
s_mov_b32 s12, s50
s_mov_b32 s13, s51
s_mov_b32 s14, 5308416
s_mov_b32 s15, 0x20000
s_mov_b32 s16, s58
s_mov_b32 s17, s59
s_mov_b32 s18, 33628160
s_mov_b32 s19, 0x20000
s_mul_i32 s69, s32, 73728
s_add_u32 s70, s69, 73728
s_cmp_eq_u32 s70, 663552
s_cselect_b32 s70, 0, s70
s_add_u32 s71, s70, 73728
s_cmp_eq_u32 s71, 663552
s_cselect_b32 s71, 0, s71
s_add_u32 s72, s71, 73728
s_cmp_eq_u32 s72, 663552
s_cselect_b32 s72, 0, s72
s_add_u32 s73, s72, 73728
s_cmp_eq_u32 s73, 663552
s_cselect_b32 s73, 0, s73
s_add_u32 s74, s73, 73728
s_cmp_eq_u32 s74, 663552
s_cselect_b32 s74, 0, s74
s_add_u32 s75, s74, 73728
s_cmp_eq_u32 s75, 663552
s_cselect_b32 s75, 0, s75
s_add_u32 s76, s75, 73728
s_cmp_eq_u32 s76, 663552
s_cselect_b32 s76, 0, s76
s_add_u32 s77, s76, 73728
s_cmp_eq_u32 s77, 663552
s_cselect_b32 s77, 0, s77
s_mov_b32 s80, 1024
s_mov_b32 s81, 65536
v_and_b32 v21, 3, v20
v_lshrrev_b32 v22, 2, v20
v_and_b32 v23, 15, v1
v_lshrrev_b32 v24, 4, v1
v_and_b32 v30, 6, v26
v_xor_b32 v30, v30, v25
v_add_u32 v29, s33, v29
v_mul_u32_u24 v9, 1152, v29
v_lshl_add_u32 v9, v30, 4, v9
v_lshrrev_b32 v29, 2, v23
v_bfe_u32 v30, v23, 1, 1
v_lshl_add_u32 v30, v21, 1, v30
v_and_b32 v31, 1, v23
v_lshlrev_b32 v31, 3, v31
v_lshl_add_u32 v32, v24, 3, v29
v_and_b32 v33, 2, v32
v_bfe_u32 v34, v32, 3, 1
v_lshl_or_b32 v33, v34, 2, v33
v_xor_b32 v33, v33, v30
v_lshlrev_b32 v33, 4, v33
v_lshl_add_u32 v2, v32, 7, v33
v_add_u32 v2, v2, v31
v_add_u32 v3, 0x10000, v2
v_add_u32 v4, 0x20000, v2
v_lshl_add_u32 v32, v24, 2, v29
v_and_b32 v33, 6, v32
v_xor_b32 v33, v33, v30
v_lshlrev_b32 v33, 4, v33
v_lshl_add_u32 v5, v32, 7, v33
v_add_u32 v5, v5, v31
v_add_u32 v6, 0x10000, v5
v_add_u32 v7, 0x20000, v5
v_lshlrev_b32 v29, 4, v1
v_lshl_add_u32 v10, v22, 11, v29
v_lshrrev_b32 v30, 1, v21
v_lshl_add_u32 v12, v30, 12, v10
v_and_b32 v30, 1, v21
v_lshl_add_u32 v12, v30, 3, v12
v_xor_b32 v30, v25, v26
v_lshlrev_b32 v30, 4, v30
v_lshl_add_u32 v13, v27, 7, v30
v_xor_b32 v30, v24, v25
v_lshlrev_b32 v30, 4, v30
v_lshl_add_u32 v30, v23, 7, v30
v_lshl_add_u32 v32, v22, 12, v30
v_xor_b32 v33, 64, v32
v_lshlrev_b32 v15, 6, v21
v_lshl_add_u32 v15, v24, 4, v15
v_add_u32 v15, 155648, v15
s_lshl_b32 s37, s26, 3
s_add_u32 s38, s37, s25
s_mul_i32 s39, s38, 73728
v_lshl_add_u32 v16, v20, 10, v29
v_add_u32 v16, s39, v16
s_mov_b32 s40, 0x409d30fc
s_mov_b32 s41, 0x3f803f80
s_mov_b32 s42, 0xffff0000
s_mov_b32 s43, 0xbeeff558
s_lshl_b32 s36, s26, 11
s_lshl_b32 s39, s25, 2
s_add_u32 s36, s36, s39
s_add_u32 s36, s36, 33554432
v_lshlrev_b32 v14, 5, v20
v_add_u32 v14, s36, v14
s_lshl_b32 s36, s25, 3
s_add_u32 s3, s36, s24
v_lshlrev_b32 v44, 4, v0
v_min_u32 v44, 4080, v44
v_add_u32 v44, 155648, v44
v_mov_b32 v1, v46
v_mov_b32 v0, v45
v_mov_b32 v38, 0
v_mov_b32 v39, 0
v_mov_b32 v40, 0
v_mov_b32 v41, 0
s_waitcnt vmcnt(9)
v_dot2c_f32_bf16 v38, s41, v60
v_dot2c_f32_bf16 v40, v60, v60
v_dot2c_f32_bf16 v39, s41, v61
v_dot2c_f32_bf16 v41, v61, v61
v_dot2c_f32_bf16 v38, s41, v62
v_dot2c_f32_bf16 v40, v62, v62
v_dot2c_f32_bf16 v39, s41, v63
v_dot2c_f32_bf16 v41, v63, v63
s_waitcnt vmcnt(8)
v_dot2c_f32_bf16 v38, s41, v64
v_dot2c_f32_bf16 v40, v64, v64
v_dot2c_f32_bf16 v39, s41, v65
v_dot2c_f32_bf16 v41, v65, v65
v_dot2c_f32_bf16 v38, s41, v66
v_dot2c_f32_bf16 v40, v66, v66
v_dot2c_f32_bf16 v39, s41, v67
v_dot2c_f32_bf16 v41, v67, v67
s_waitcnt vmcnt(7)
v_dot2c_f32_bf16 v38, s41, v68
v_dot2c_f32_bf16 v40, v68, v68
v_dot2c_f32_bf16 v39, s41, v69
v_dot2c_f32_bf16 v41, v69, v69
v_dot2c_f32_bf16 v38, s41, v70
v_dot2c_f32_bf16 v40, v70, v70
v_dot2c_f32_bf16 v39, s41, v71
v_dot2c_f32_bf16 v41, v71, v71
s_waitcnt vmcnt(6)
v_dot2c_f32_bf16 v38, s41, v84
v_dot2c_f32_bf16 v40, v84, v84
v_dot2c_f32_bf16 v39, s41, v85
v_dot2c_f32_bf16 v41, v85, v85
v_dot2c_f32_bf16 v38, s41, v86
v_dot2c_f32_bf16 v40, v86, v86
v_dot2c_f32_bf16 v39, s41, v87
v_dot2c_f32_bf16 v41, v87, v87
s_add_u32 m0, s34, 73728
s_add_u32 s35, s60, s78
buffer_load_dwordx4 v8, s[8:11], s35 offen  lds
s_waitcnt vmcnt(6)
v_dot2c_f32_bf16 v38, s41, v88
v_dot2c_f32_bf16 v40, v88, v88
v_dot2c_f32_bf16 v39, s41, v89
v_dot2c_f32_bf16 v41, v89, v89
v_dot2c_f32_bf16 v38, s41, v90
v_dot2c_f32_bf16 v40, v90, v90
v_dot2c_f32_bf16 v39, s41, v91
v_dot2c_f32_bf16 v41, v91, v91
s_add_u32 m0, s34, 81920
s_add_u32 s35, s61, s78
buffer_load_dwordx4 v8, s[8:11], s35 offen  lds
s_waitcnt vmcnt(6)
v_dot2c_f32_bf16 v38, s41, v92
v_dot2c_f32_bf16 v40, v92, v92
v_dot2c_f32_bf16 v39, s41, v93
v_dot2c_f32_bf16 v41, v93, v93
v_dot2c_f32_bf16 v38, s41, v94
v_dot2c_f32_bf16 v40, v94, v94
v_dot2c_f32_bf16 v39, s41, v95
v_dot2c_f32_bf16 v41, v95, v95
s_add_u32 m0, s34, 90112
s_add_u32 s35, s62, s78
buffer_load_dwordx4 v8, s[8:11], s35 offen  lds
s_waitcnt vmcnt(6)
v_dot2c_f32_bf16 v38, s41, v96
v_dot2c_f32_bf16 v40, v96, v96
v_dot2c_f32_bf16 v39, s41, v97
v_dot2c_f32_bf16 v41, v97, v97
v_dot2c_f32_bf16 v38, s41, v98
v_dot2c_f32_bf16 v40, v98, v98
v_dot2c_f32_bf16 v39, s41, v99
v_dot2c_f32_bf16 v41, v99, v99
s_add_u32 m0, s34, 98304
s_add_u32 s35, s63, s78
buffer_load_dwordx4 v8, s[8:11], s35 offen  lds
s_waitcnt vmcnt(6)
v_dot2c_f32_bf16 v38, s41, v100
v_dot2c_f32_bf16 v40, v100, v100
v_dot2c_f32_bf16 v39, s41, v101
v_dot2c_f32_bf16 v41, v101, v101
v_dot2c_f32_bf16 v38, s41, v102
v_dot2c_f32_bf16 v40, v102, v102
v_dot2c_f32_bf16 v39, s41, v103
v_dot2c_f32_bf16 v41, v103, v103
s_add_u32 m0, s34, 106496
s_add_u32 s35, s64, s78
buffer_load_dwordx4 v8, s[8:11], s35 offen  lds
s_waitcnt vmcnt(6)
v_dot2c_f32_bf16 v38, s41, v104
v_dot2c_f32_bf16 v40, v104, v104
v_dot2c_f32_bf16 v39, s41, v105
v_dot2c_f32_bf16 v41, v105, v105
v_dot2c_f32_bf16 v38, s41, v106
v_dot2c_f32_bf16 v40, v106, v106
v_dot2c_f32_bf16 v39, s41, v107
v_dot2c_f32_bf16 v41, v107, v107
s_add_u32 m0, s34, 114688
s_add_u32 s35, s65, s78
buffer_load_dwordx4 v8, s[8:11], s35 offen  lds
s_nop 2
v_add_f32 v38, v38, v39
v_add_f32 v39, v40, v41
s_nop 0
v_add_f32_dpp v38, v38, v38 quad_perm:[1,0,3,2] row_mask:0xf bank_mask:0xf
v_add_f32_dpp v39, v39, v39 quad_perm:[1,0,3,2] row_mask:0xf bank_mask:0xf
s_nop 0
v_add_f32_dpp v38, v38, v38 quad_perm:[2,3,0,1] row_mask:0xf bank_mask:0xf
v_add_f32_dpp v39, v39, v39 quad_perm:[2,3,0,1] row_mask:0xf bank_mask:0xf
s_nop 0
v_add_f32_dpp v38, v38, v38 row_half_mirror row_mask:0xf bank_mask:0xf
v_add_f32_dpp v39, v39, v39 row_half_mirror row_mask:0xf bank_mask:0xf
s_nop 0
v_mul_f32 v38, 0x3ae38e39, v38
v_mul_f32 v39, 0x3ae38e39, v39
v_fma_f32 v39, -v38, v38, v39
v_max_f32 v39, 0, v39
v_add_f32 v39, 0x3727c5ac, v39
v_rsq_f32 v39, v39
s_nop 0
v_mul_f32 v108, s43, v39
v_mul_f32 v110, v38, v108
v_sub_f32 v110, 0, v110
v_lshlrev_b32 v72, 16, v60
v_and_b32 v73, s42, v60
v_lshlrev_b32 v74, 16, v61
v_and_b32 v75, s42, v61
v_lshlrev_b32 v76, 16, v62
v_and_b32 v77, s42, v62
v_lshlrev_b32 v78, 16, v63
v_and_b32 v79, s42, v63
v_pk_fma_f32 v[72:73], v[72:73], v[108:109], v[110:111] op_sel_hi:[1,0,0]
v_pk_fma_f32 v[74:75], v[74:75], v[108:109], v[110:111] op_sel_hi:[1,0,0]
v_pk_fma_f32 v[76:77], v[76:77], v[108:109], v[110:111] op_sel_hi:[1,0,0]
v_pk_fma_f32 v[78:79], v[78:79], v[108:109], v[110:111] op_sel_hi:[1,0,0]
v_cvt_pk_bf16_f32 v60, v72, v73
v_cvt_pk_bf16_f32 v61, v74, v75
v_cvt_pk_bf16_f32 v62, v76, v77
v_cvt_pk_bf16_f32 v63, v78, v79
ds_write_b128 v13, v[60:63] offset:0
v_lshlrev_b32 v72, 16, v64
v_and_b32 v73, s42, v64
v_lshlrev_b32 v74, 16, v65
v_and_b32 v75, s42, v65
v_lshlrev_b32 v76, 16, v66
v_and_b32 v77, s42, v66
v_lshlrev_b32 v78, 16, v67
v_and_b32 v79, s42, v67
v_pk_fma_f32 v[72:73], v[72:73], v[108:109], v[110:111] op_sel_hi:[1,0,0]
v_pk_fma_f32 v[74:75], v[74:75], v[108:109], v[110:111] op_sel_hi:[1,0,0]
v_pk_fma_f32 v[76:77], v[76:77], v[108:109], v[110:111] op_sel_hi:[1,0,0]
v_pk_fma_f32 v[78:79], v[78:79], v[108:109], v[110:111] op_sel_hi:[1,0,0]
v_cvt_pk_bf16_f32 v64, v72, v73
v_cvt_pk_bf16_f32 v65, v74, v75
v_cvt_pk_bf16_f32 v66, v76, v77
v_cvt_pk_bf16_f32 v67, v78, v79
ds_write_b128 v13, v[64:67] offset:8192
v_lshlrev_b32 v72, 16, v68
v_and_b32 v73, s42, v68
v_lshlrev_b32 v74, 16, v69
v_and_b32 v75, s42, v69
v_lshlrev_b32 v76, 16, v70
v_and_b32 v77, s42, v70
v_lshlrev_b32 v78, 16, v71
v_and_b32 v79, s42, v71
v_pk_fma_f32 v[72:73], v[72:73], v[108:109], v[110:111] op_sel_hi:[1,0,0]
v_pk_fma_f32 v[74:75], v[74:75], v[108:109], v[110:111] op_sel_hi:[1,0,0]
v_pk_fma_f32 v[76:77], v[76:77], v[108:109], v[110:111] op_sel_hi:[1,0,0]
v_pk_fma_f32 v[78:79], v[78:79], v[108:109], v[110:111] op_sel_hi:[1,0,0]
v_cvt_pk_bf16_f32 v68, v72, v73
v_cvt_pk_bf16_f32 v69, v74, v75
v_cvt_pk_bf16_f32 v70, v76, v77
v_cvt_pk_bf16_f32 v71, v78, v79
ds_write_b128 v13, v[68:71] offset:16384
v_lshlrev_b32 v72, 16, v84
v_and_b32 v73, s42, v84
v_lshlrev_b32 v74, 16, v85
v_and_b32 v75, s42, v85
v_lshlrev_b32 v76, 16, v86
v_and_b32 v77, s42, v86
v_lshlrev_b32 v78, 16, v87
v_and_b32 v79, s42, v87
v_pk_fma_f32 v[72:73], v[72:73], v[108:109], v[110:111] op_sel_hi:[1,0,0]
v_pk_fma_f32 v[74:75], v[74:75], v[108:109], v[110:111] op_sel_hi:[1,0,0]
v_pk_fma_f32 v[76:77], v[76:77], v[108:109], v[110:111] op_sel_hi:[1,0,0]
v_pk_fma_f32 v[78:79], v[78:79], v[108:109], v[110:111] op_sel_hi:[1,0,0]
v_cvt_pk_bf16_f32 v84, v72, v73
v_cvt_pk_bf16_f32 v85, v74, v75
v_cvt_pk_bf16_f32 v86, v76, v77
v_cvt_pk_bf16_f32 v87, v78, v79
ds_write_b128 v13, v[84:87] offset:24576
v_lshlrev_b32 v72, 16, v88
v_and_b32 v73, s42, v88
v_lshlrev_b32 v74, 16, v89
v_and_b32 v75, s42, v89
v_lshlrev_b32 v76, 16, v90
v_and_b32 v77, s42, v90
v_lshlrev_b32 v78, 16, v91
v_and_b32 v79, s42, v91
v_pk_fma_f32 v[72:73], v[72:73], v[108:109], v[110:111] op_sel_hi:[1,0,0]
v_pk_fma_f32 v[74:75], v[74:75], v[108:109], v[110:111] op_sel_hi:[1,0,0]
v_pk_fma_f32 v[76:77], v[76:77], v[108:109], v[110:111] op_sel_hi:[1,0,0]
v_pk_fma_f32 v[78:79], v[78:79], v[108:109], v[110:111] op_sel_hi:[1,0,0]
v_cvt_pk_bf16_f32 v88, v72, v73
v_cvt_pk_bf16_f32 v89, v74, v75
v_cvt_pk_bf16_f32 v90, v76, v77
v_cvt_pk_bf16_f32 v91, v78, v79
ds_write_b128 v13, v[88:91] offset:32768
v_lshlrev_b32 v72, 16, v92
v_and_b32 v73, s42, v92
v_lshlrev_b32 v74, 16, v93
v_and_b32 v75, s42, v93
v_lshlrev_b32 v76, 16, v94
v_and_b32 v77, s42, v94
v_lshlrev_b32 v78, 16, v95
v_and_b32 v79, s42, v95
v_pk_fma_f32 v[72:73], v[72:73], v[108:109], v[110:111] op_sel_hi:[1,0,0]
v_pk_fma_f32 v[74:75], v[74:75], v[108:109], v[110:111] op_sel_hi:[1,0,0]
v_pk_fma_f32 v[76:77], v[76:77], v[108:109], v[110:111] op_sel_hi:[1,0,0]
v_pk_fma_f32 v[78:79], v[78:79], v[108:109], v[110:111] op_sel_hi:[1,0,0]
v_cvt_pk_bf16_f32 v92, v72, v73
v_cvt_pk_bf16_f32 v93, v74, v75
v_cvt_pk_bf16_f32 v94, v76, v77
v_cvt_pk_bf16_f32 v95, v78, v79
ds_write_b128 v13, v[92:95] offset:40960
v_lshlrev_b32 v72, 16, v96
v_and_b32 v73, s42, v96
v_lshlrev_b32 v74, 16, v97
v_and_b32 v75, s42, v97
v_lshlrev_b32 v76, 16, v98
v_and_b32 v77, s42, v98
v_lshlrev_b32 v78, 16, v99
v_and_b32 v79, s42, v99
v_pk_fma_f32 v[72:73], v[72:73], v[108:109], v[110:111] op_sel_hi:[1,0,0]
v_pk_fma_f32 v[74:75], v[74:75], v[108:109], v[110:111] op_sel_hi:[1,0,0]
v_pk_fma_f32 v[76:77], v[76:77], v[108:109], v[110:111] op_sel_hi:[1,0,0]
v_pk_fma_f32 v[78:79], v[78:79], v[108:109], v[110:111] op_sel_hi:[1,0,0]
v_cvt_pk_bf16_f32 v96, v72, v73
v_cvt_pk_bf16_f32 v97, v74, v75
v_cvt_pk_bf16_f32 v98, v76, v77
v_cvt_pk_bf16_f32 v99, v78, v79
ds_write_b128 v13, v[96:99] offset:49152
v_lshlrev_b32 v72, 16, v100
v_and_b32 v73, s42, v100
v_lshlrev_b32 v74, 16, v101
v_and_b32 v75, s42, v101
v_lshlrev_b32 v76, 16, v102
v_and_b32 v77, s42, v102
v_lshlrev_b32 v78, 16, v103
v_and_b32 v79, s42, v103
v_pk_fma_f32 v[72:73], v[72:73], v[108:109], v[110:111] op_sel_hi:[1,0,0]
v_pk_fma_f32 v[74:75], v[74:75], v[108:109], v[110:111] op_sel_hi:[1,0,0]
v_pk_fma_f32 v[76:77], v[76:77], v[108:109], v[110:111] op_sel_hi:[1,0,0]
v_pk_fma_f32 v[78:79], v[78:79], v[108:109], v[110:111] op_sel_hi:[1,0,0]
v_cvt_pk_bf16_f32 v100, v72, v73
v_cvt_pk_bf16_f32 v101, v74, v75
v_cvt_pk_bf16_f32 v102, v76, v77
v_cvt_pk_bf16_f32 v103, v78, v79
ds_write_b128 v13, v[100:103] offset:57344
v_lshlrev_b32 v72, 16, v104
v_and_b32 v73, s42, v104
v_lshlrev_b32 v74, 16, v105
v_and_b32 v75, s42, v105
v_lshlrev_b32 v76, 16, v106
v_and_b32 v77, s42, v106
v_lshlrev_b32 v78, 16, v107
v_and_b32 v79, s42, v107
v_pk_fma_f32 v[72:73], v[72:73], v[108:109], v[110:111] op_sel_hi:[1,0,0]
v_pk_fma_f32 v[74:75], v[74:75], v[108:109], v[110:111] op_sel_hi:[1,0,0]
v_pk_fma_f32 v[76:77], v[76:77], v[108:109], v[110:111] op_sel_hi:[1,0,0]
v_pk_fma_f32 v[78:79], v[78:79], v[108:109], v[110:111] op_sel_hi:[1,0,0]
v_cvt_pk_bf16_f32 v104, v72, v73
v_cvt_pk_bf16_f32 v105, v74, v75
v_cvt_pk_bf16_f32 v106, v76, v77
v_cvt_pk_bf16_f32 v107, v78, v79
v_add_u32 v17, 0x10000, v13
ds_write_b128 v17, v[104:107] offset:0
s_waitcnt vmcnt(6)
v_lshlrev_b32 v40, 16, v36
v_and_b32 v41, s42, v36
v_lshlrev_b32 v42, 16, v37
v_and_b32 v43, s42, v37
v_mul_f32 v40, s43, v40
v_mul_f32 v41, s43, v41
v_mul_f32 v42, s43, v42
v_mul_f32 v43, s43, v43
s_cmp_gt_u32 s24, 2
s_cbranch_scc1 standalone__mixer_channel_mlp__prompt_kernel_nobias
ds_write_b128 v44, v[40:43]
standalone__mixer_channel_mlp__prompt_kernel_nobias:
s_add_u32 m0, s34, 122880
s_add_u32 s35, s66, s78
buffer_load_dwordx4 v8, s[8:11], s35 offen  lds
s_add_u32 m0, s34, 131072
s_add_u32 s35, s67, s78
buffer_load_dwordx4 v8, s[8:11], s35 offen  lds
s_add_u32 m0, s34, 139264
s_add_u32 s35, s68, s78
buffer_load_dwordx4 v8, s[8:11], s35 offen  lds
s_add_u32 s78, s78, 128
s_cmp_eq_u32 s78, 1152
s_cselect_b32 s78, 0, s78
s_add_u32 m0, s34, 147456
s_add_u32 s35, s60, s78
buffer_load_dwordx4 v8, s[8:11], s35 offen  lds
s_waitcnt vmcnt(4) lgkmcnt(0)
s_barrier
s_lshr_b32 s27, s24, 2
s_mov_b32 vcc_lo, s27
s_mov_b32 vcc_hi, 0
v_add_u32 v80, s79, v15
ds_read_b128 v[80:83], v80
ds_read_b64_tr_b16 v[36:37], v3 offset:8192
ds_read_b64_tr_b16 v[38:39], v3 offset:8704
ds_read_b64_tr_b16 v[40:41], v3 offset:12288
ds_read_b64_tr_b16 v[42:43], v3 offset:12800
ds_read_b128 a[0:3], v32 offset:0
ds_read_b128 a[4:7], v32 offset:2048
ds_read_b128 a[8:11], v33 offset:0
ds_read_b128 a[12:15], v33 offset:2048
ds_read_b64_tr_b16 v[44:45], v3 offset:16384
ds_read_b64_tr_b16 v[46:47], v3 offset:16896
ds_read_b128 a[16:19], v32 offset:8192
ds_read_b128 a[20:23], v32 offset:10240
ds_read_b128 a[24:27], v33 offset:8192
ds_read_b128 a[28:31], v33 offset:10240
ds_read_b64_tr_b16 v[48:49], v3 offset:20480
ds_read_b64_tr_b16 v[50:51], v3 offset:20992
ds_read_b64_tr_b16 v[52:53], v3 offset:24576
ds_read_b64_tr_b16 v[54:55], v3 offset:25088
ds_read_b64_tr_b16 v[56:57], v3 offset:28672
ds_read_b64_tr_b16 v[58:59], v3 offset:29184
ds_read_b128 a[32:35], v32 offset:16384
ds_read_b128 a[36:39], v32 offset:18432
ds_read_b128 a[40:43], v33 offset:16384
ds_read_b128 a[44:47], v33 offset:18432
s_lshr_b32 s36, s24, 0
s_cmp_lg_u32 s36, 0
s_cbranch_scc1 standalone__mixer_channel_mlp__prompt_kernel_nopf0
buffer_load_dword v0, v0, s[8:11], 0 offen
standalone__mixer_channel_mlp__prompt_kernel_nopf0:
s_lshr_b32 s36, s24, 0
s_cmp_lg_u32 s36, 1
s_cbranch_scc1 standalone__mixer_channel_mlp__prompt_kernel_nopf1
buffer_load_dword v0, v0, s[8:11], 0 offen
standalone__mixer_channel_mlp__prompt_kernel_nopf1:
s_lshr_b32 s36, s24, 0
s_cmp_lg_u32 s36, 2
s_cbranch_scc1 standalone__mixer_channel_mlp__prompt_kernel_nopf2
buffer_load_dword v0, v0, s[8:11], 0 offen
standalone__mixer_channel_mlp__prompt_kernel_nopf2:
s_cmp_lg_u32 s3, 7
s_cbranch_scc1 standalone__mixer_channel_mlp__prompt_kernel_nolead
v_mbcnt_lo_u32_b32 v17, -1, 0
v_mbcnt_hi_u32_b32 v17, -1, v17
s_lshl_b32 s36, s26, 11
s_add_u32 s36, s36, 33554432
v_lshlrev_b32 v18, 4, v17
v_lshlrev_b32 v17, 2, v17
buffer_load_dwordx4 v[84:87], v18, s[16:19], s36 offen sc1
buffer_load_dwordx4 v[88:91], v18, s[16:19], s36 offen offset:1024 sc1
s_lshl_b32 s36, s26, 8
s_add_u32 s36, s36, 33619968
buffer_load_dword v92, v17, s[16:19], s36 offen sc1
standalone__mixer_channel_mlp__prompt_kernel_nolead:
s_waitcnt lgkmcnt(15)
v_mfma_f32_16x16x32_bf16 v[20:23], v[36:39], a[0:3], v[80:83]
ds_read_b64_tr_b16 v[60:61], v3 offset:32768
ds_read_b128 a[48:51], v32 offset:24576
ds_read_b128 a[52:55], v32 offset:26624
v_mfma_f32_16x16x32_bf16 v[20:23], v[40:43], a[8:11], v[20:23]
ds_read_b64_tr_b16 v[62:63], v3 offset:33280
ds_read_b128 a[56:59], v33 offset:24576
s_waitcnt lgkmcnt(15)
v_mfma_f32_16x16x32_bf16 v[20:23], v[44:47], a[16:19], v[20:23]
ds_read_b64_tr_b16 v[64:65], v3 offset:36864
ds_read_b128 a[60:63], v33 offset:26624
v_mfma_f32_16x16x32_bf16 v[24:27], v[36:39], a[4:7], v[80:83]
ds_read_b64_tr_b16 v[66:67], v3 offset:37376
ds_read_b128 a[64:67], v32 offset:32768
v_mfma_f32_16x16x32_bf16 v[24:27], v[40:43], a[12:15], v[24:27]
ds_read_b64_tr_b16 v[68:69], v3 offset:40960
ds_read_b128 a[68:71], v32 offset:34816
v_mfma_f32_16x16x32_bf16 v[24:27], v[44:47], a[20:23], v[24:27]
ds_read_b64_tr_b16 v[70:71], v3 offset:41472
ds_read_b128 a[72:75], v33 offset:32768
ds_read_b128 a[76:79], v33 offset:34816
s_waitcnt lgkmcnt(15)
v_mfma_f32_16x16x32_bf16 v[20:23], v[48:51], a[24:27], v[20:23]
ds_read_b64_tr_b16 v[36:37], v3 offset:45056
ds_read_b128 a[80:83], v32 offset:40960
s_waitcnt lgkmcnt(15)
v_mfma_f32_16x16x32_bf16 v[20:23], v[52:55], a[32:35], v[20:23]
ds_read_b64_tr_b16 v[38:39], v3 offset:45568
ds_read_b128 a[84:87], v32 offset:43008
v_mfma_f32_16x16x32_bf16 v[20:23], v[56:59], a[40:43], v[20:23]
ds_read_b64_tr_b16 v[40:41], v3 offset:49152
ds_read_b128 a[88:91], v33 offset:40960
v_mfma_f32_16x16x32_bf16 v[24:27], v[48:51], a[28:31], v[24:27]
ds_read_b64_tr_b16 v[42:43], v3 offset:49664
ds_read_b128 a[92:95], v33 offset:43008
v_mfma_f32_16x16x32_bf16 v[24:27], v[52:55], a[36:39], v[24:27]
ds_read_b64_tr_b16 v[44:45], v3 offset:53248
v_mfma_f32_16x16x32_bf16 v[24:27], v[56:59], a[44:47], v[24:27]
ds_read_b64_tr_b16 v[46:47], v3 offset:53760
s_waitcnt vmcnt(1) lgkmcnt(2)
s_barrier
v_mfma_f32_16x16x32_bf16 v[20:23], v[60:63], a[48:51], v[20:23]
ds_read_b64_tr_b16 v[48:49], v3 offset:57344
ds_read_b128 a[96:99], v32 offset:49152
ds_read_b128 a[100:103], v32 offset:51200
v_mfma_f32_16x16x32_bf16 v[20:23], v[64:67], a[56:59], v[20:23]
s_add_u32 m0, s34, 0
s_add_u32 s35, s61, s78
buffer_load_dwordx4 v8, s[8:11], s35 offen  lds
ds_read_b64_tr_b16 v[50:51], v3 offset:57856
ds_read_b128 a[104:107], v33 offset:49152
v_mfma_f32_16x16x32_bf16 v[20:23], v[68:71], a[64:67], v[20:23]
ds_read_b64_tr_b16 v[52:53], v3 offset:61440
ds_read_b128 a[108:111], v33 offset:51200
v_mfma_f32_16x16x32_bf16 v[24:27], v[60:63], a[52:55], v[24:27]
s_add_u32 m0, s34, 8192
s_add_u32 s35, s62, s78
buffer_load_dwordx4 v8, s[8:11], s35 offen  lds
ds_read_b64_tr_b16 v[54:55], v3 offset:61952
ds_read_b128 a[112:115], v32 offset:57344
v_mfma_f32_16x16x32_bf16 v[24:27], v[64:67], a[60:63], v[24:27]
ds_read_b64_tr_b16 v[56:57], v4 offset:0
ds_read_b128 a[116:119], v32 offset:59392
v_mfma_f32_16x16x32_bf16 v[24:27], v[68:71], a[68:71], v[24:27]
s_add_u32 m0, s34, 16384
s_add_u32 s35, s63, s78
buffer_load_dwordx4 v8, s[8:11], s35 offen  lds
ds_read_b64_tr_b16 v[58:59], v4 offset:512
ds_read_b128 a[120:123], v33 offset:57344
ds_read_b128 a[124:127], v33 offset:59392
v_mfma_f32_16x16x32_bf16 v[20:23], v[36:39], a[72:75], v[20:23]
ds_read_b64_tr_b16 v[60:61], v4 offset:4096
v_add_u32 v18, 0x10000, v32
ds_read_b128 a[128:131], v18 offset:0
v_mfma_f32_16x16x32_bf16 v[20:23], v[40:43], a[80:83], v[20:23]
ds_read_b64_tr_b16 v[62:63], v4 offset:4608
v_add_u32 v19, 0x10000, v32
ds_read_b128 a[132:135], v19 offset:2048
s_waitcnt lgkmcnt(15)
v_mfma_f32_16x16x32_bf16 v[20:23], v[44:47], a[88:91], v[20:23]
s_add_u32 m0, s34, 24576
s_add_u32 s35, s64, s78
buffer_load_dwordx4 v8, s[8:11], s35 offen  lds
ds_read_b64_tr_b16 v[64:65], v4 offset:8192
v_add_u32 v17, 0x10000, v33
ds_read_b128 a[136:139], v17 offset:0
v_mfma_f32_16x16x32_bf16 v[24:27], v[36:39], a[76:79], v[24:27]
ds_read_b64_tr_b16 v[66:67], v4 offset:8704
v_add_u32 v18, 0x10000, v33
ds_read_b128 a[140:143], v18 offset:2048
v_mfma_f32_16x16x32_bf16 v[24:27], v[40:43], a[84:87], v[24:27]
s_add_u32 m0, s34, 32768
s_add_u32 s35, s65, s78
buffer_load_dwordx4 v8, s[8:11], s35 offen  lds
ds_read_b64_tr_b16 v[68:69], v4 offset:12288
v_mfma_f32_16x16x32_bf16 v[24:27], v[44:47], a[92:95], v[24:27]
ds_read_b64_tr_b16 v[70:71], v4 offset:12800
s_waitcnt vmcnt(3) lgkmcnt(2)
s_barrier
v_mfma_f32_16x16x32_bf16 v[20:23], v[48:51], a[96:99], v[20:23]
ds_read_b64_tr_b16 v[36:37], v4 offset:16384
v_mfma_f32_16x16x32_bf16 v[20:23], v[52:55], a[104:107], v[20:23]
s_add_u32 m0, s34, 40960
s_add_u32 s35, s66, s78
buffer_load_dwordx4 v8, s[8:11], s35 offen  lds
ds_read_b64_tr_b16 v[38:39], v4 offset:16896
v_mfma_f32_16x16x32_bf16 v[20:23], v[56:59], a[112:115], v[20:23]
ds_read_b64_tr_b16 v[40:41], v4 offset:20480
v_mfma_f32_16x16x32_bf16 v[24:27], v[48:51], a[100:103], v[24:27]
s_add_u32 m0, s34, 49152
s_add_u32 s35, s67, s78
buffer_load_dwordx4 v8, s[8:11], s35 offen  lds
ds_read_b64_tr_b16 v[42:43], v4 offset:20992
v_mfma_f32_16x16x32_bf16 v[24:27], v[52:55], a[108:111], v[24:27]
ds_read_b64_tr_b16 v[44:45], v2 offset:0
v_mfma_f32_16x16x32_bf16 v[24:27], v[56:59], a[116:119], v[24:27]
s_add_u32 m0, s34, 57344
s_add_u32 s35, s68, s78
buffer_load_dwordx4 v8, s[8:11], s35 offen  lds
ds_read_b64_tr_b16 v[46:47], v2 offset:512
s_add_u32 s79, s79, 256
s_cmp_eq_u32 s79, 2304
s_cselect_b32 s79, 0, s79
v_add_u32 v80, s79, v15
ds_read_b128 v[80:83], v80
v_mfma_f32_16x16x32_bf16 v[20:23], v[60:63], a[120:123], v[20:23]
ds_read_b64_tr_b16 v[48:49], v2 offset:4096
v_mfma_f32_16x16x32_bf16 v[20:23], v[64:67], a[128:131], v[20:23]
ds_read_b64_tr_b16 v[50:51], v2 offset:4608
s_waitcnt lgkmcnt(9)
v_mfma_f32_16x16x32_bf16 v[20:23], v[68:71], a[136:139], v[20:23]
s_add_u32 s78, s78, 128
s_cmp_eq_u32 s78, 1152
s_cselect_b32 s78, 0, s78
s_add_u32 m0, s34, 65536
s_add_u32 s35, s60, s78
buffer_load_dwordx4 v8, s[8:11], s35 offen  lds
ds_read_b64_tr_b16 v[52:53], v2 offset:8192
v_mfma_f32_16x16x32_bf16 v[24:27], v[60:63], a[124:127], v[24:27]
ds_read_b64_tr_b16 v[54:55], v2 offset:8704
v_mfma_f32_16x16x32_bf16 v[24:27], v[64:67], a[132:135], v[24:27]
s_add_u32 m0, s34, 73728
s_add_u32 s35, s61, s78
buffer_load_dwordx4 v8, s[8:11], s35 offen  lds
ds_read_b64_tr_b16 v[56:57], v2 offset:12288
v_mfma_f32_16x16x32_bf16 v[24:27], v[68:71], a[140:143], v[24:27]
ds_read_b64_tr_b16 v[58:59], v2 offset:12800
s_waitcnt vmcnt(5)
s_barrier
s_waitcnt lgkmcnt(6)
v_mfma_f32_16x16x32_bf16 v[28:31], v[36:39], a[0:3], v[80:83]
ds_read_b64_tr_b16 v[60:61], v2 offset:16384
v_mfma_f32_16x16x32_bf16 v[28:31], v[40:43], a[8:11], v[28:31]
s_add_u32 m0, s34, 81920
s_add_u32 s35, s62, s78
buffer_load_dwordx4 v8, s[8:11], s35 offen  lds
ds_read_b64_tr_b16 v[62:63], v2 offset:16896
v_mfma_f32_16x16x32_bf16 v[28:31], v[44:47], a[16:19], v[28:31]
ds_read_b64_tr_b16 v[64:65], v2 offset:20480
v_mfma_f32_16x16x32_bf16 v[32:35], v[36:39], a[4:7], v[80:83]
s_add_u32 m0, s34, 90112
s_add_u32 s35, s63, s78
buffer_load_dwordx4 v8, s[8:11], s35 offen  lds
ds_read_b64_tr_b16 v[66:67], v2 offset:20992
v_fma_f32 v72, v20, v20, s40
v_fma_f32 v73, v21, v21, s40
v_fma_f32 v74, v22, v22, s40
v_mfma_f32_16x16x32_bf16 v[32:35], v[40:43], a[12:15], v[32:35]
ds_read_b64_tr_b16 v[68:69], v2 offset:24576
v_fma_f32 v75, v23, v23, s40
v_fma_f32 v76, v24, v24, s40
v_mfma_f32_16x16x32_bf16 v[32:35], v[44:47], a[20:23], v[32:35]
s_add_u32 m0, s34, 98304
s_add_u32 s35, s64, s78
buffer_load_dwordx4 v8, s[8:11], s35 offen  lds
ds_read_b64_tr_b16 v[70:71], v2 offset:25088
v_fma_f32 v77, v25, v25, s40
v_fma_f32 v78, v26, v26, s40
s_waitcnt lgkmcnt(10)
v_mfma_f32_16x16x32_bf16 v[28:31], v[48:51], a[24:27], v[28:31]
ds_read_b64_tr_b16 v[36:37], v2 offset:28672
v_fma_f32 v79, v27, v27, s40
v_mul_f32 v72, v20, v72
s_waitcnt lgkmcnt(9)
v_mfma_f32_16x16x32_bf16 v[28:31], v[52:55], a[32:35], v[28:31]
ds_read_b64_tr_b16 v[38:39], v2 offset:29184
v_mul_f32 v73, v21, v73
v_mul_f32 v74, v22, v74
s_waitcnt lgkmcnt(8)
v_mfma_f32_16x16x32_bf16 v[28:31], v[56:59], a[40:43], v[28:31]
s_add_u32 m0, s34, 106496
s_add_u32 s35, s65, s78
buffer_load_dwordx4 v8, s[8:11], s35 offen  lds
ds_read_b64_tr_b16 v[40:41], v2 offset:32768
v_mul_f32 v75, v23, v75
v_mul_f32 v76, v24, v76
v_mfma_f32_16x16x32_bf16 v[32:35], v[48:51], a[28:31], v[32:35]
ds_read_b64_tr_b16 v[42:43], v2 offset:33280
v_mul_f32 v77, v25, v77
v_mul_f32 v78, v26, v78
v_mfma_f32_16x16x32_bf16 v[32:35], v[52:55], a[36:39], v[32:35]
s_add_u32 m0, s34, 114688
s_add_u32 s35, s66, s78
buffer_load_dwordx4 v8, s[8:11], s35 offen  lds
ds_read_b64_tr_b16 v[44:45], v2 offset:36864
v_mul_f32 v79, v27, v79
v_exp_f32 v72, v72
v_mfma_f32_16x16x32_bf16 v[32:35], v[56:59], a[44:47], v[32:35]
ds_read_b64_tr_b16 v[46:47], v2 offset:37376
v_exp_f32 v73, v73
s_waitcnt vmcnt(7)
s_barrier
s_cmp_lg_u32 s3, 7
s_cbranch_scc1 standalone__mixer_channel_mlp__prompt_kernel_nolead2
s_waitcnt vmcnt(15)
s_mov_b32 s36, 0
standalone__mixer_channel_mlp__prompt_kernel_ep:
s_add_u32 s36, s36, 1
s_mov_b64 s[28:29], 0
v_cmp_eq_u32 vcc, s36, v84
s_or_b64 s[28:29], s[28:29], vcc
v_cmp_eq_u32 vcc, s36, v85
s_or_b64 s[28:29], s[28:29], vcc
v_cmp_eq_u32 vcc, s36, v86
s_or_b64 s[28:29], s[28:29], vcc
v_cmp_eq_u32 vcc, s36, v87
s_or_b64 s[28:29], s[28:29], vcc
v_cmp_eq_u32 vcc, s36, v88
s_or_b64 s[28:29], s[28:29], vcc
v_cmp_eq_u32 vcc, s36, v89
s_or_b64 s[28:29], s[28:29], vcc
v_cmp_eq_u32 vcc, s36, v90
s_or_b64 s[28:29], s[28:29], vcc
v_cmp_eq_u32 vcc, s36, v91
s_or_b64 s[28:29], s[28:29], vcc
v_cmp_eq_u32 vcc, s36, v92
s_or_b64 s[28:29], s[28:29], vcc
s_cbranch_scc1 standalone__mixer_channel_mlp__prompt_kernel_ep
s_lshl_b32 s39, s26, 2
v_mov_b32 v17, s39
v_mov_b32 v18, s36
s_mov_b64 exec, 1
global_store_dword v17, v18, s[56:57] sc1
s_mov_b64 exec, -1
s_mov_b32 vcc_lo, s27
s_mov_b32 vcc_hi, 0
standalone__mixer_channel_mlp__prompt_kernel_nolead2:
s_waitcnt lgkmcnt(10)
v_mfma_f32_16x16x32_bf16 v[28:31], v[60:63], a[48:51], v[28:31]
ds_read_b64_tr_b16 v[48:49], v2 offset:40960
v_exp_f32 v74, v74
s_waitcnt lgkmcnt(9)
v_mfma_f32_16x16x32_bf16 v[28:31], v[64:67], a[56:59], v[28:31]
s_add_u32 m0, s34, 0
s_add_u32 s35, s67, s78
buffer_load_dwordx4 v8, s[8:11], s35 offen  lds
ds_read_b64_tr_b16 v[50:51], v2 offset:41472
v_exp_f32 v75, v75
s_waitcnt lgkmcnt(8)
v_mfma_f32_16x16x32_bf16 v[28:31], v[68:71], a[64:67], v[28:31]
ds_read_b64_tr_b16 v[52:53], v2 offset:45056
v_exp_f32 v76, v76
v_mfma_f32_16x16x32_bf16 v[32:35], v[60:63], a[52:55], v[32:35]
s_add_u32 m0, s34, 8192
s_add_u32 s35, s68, s78
buffer_load_dwordx4 v8, s[8:11], s35 offen  lds
ds_read_b64_tr_b16 v[54:55], v2 offset:45568
v_exp_f32 v77, v77
v_mfma_f32_16x16x32_bf16 v[32:35], v[64:67], a[60:63], v[32:35]
ds_read_b64_tr_b16 v[56:57], v2 offset:49152
v_exp_f32 v78, v78
v_mfma_f32_16x16x32_bf16 v[32:35], v[68:71], a[68:71], v[32:35]
s_add_u32 s78, s78, 128
s_cmp_eq_u32 s78, 1152
s_cselect_b32 s78, 0, s78
s_add_u32 m0, s34, 122880
s_add_u32 s35, s60, s78
buffer_load_dwordx4 v8, s[8:11], s35 offen  lds
ds_read_b64_tr_b16 v[58:59], v2 offset:49664
v_exp_f32 v79, v79
s_waitcnt lgkmcnt(10)
v_mfma_f32_16x16x32_bf16 v[28:31], v[36:39], a[72:75], v[28:31]
ds_read_b64_tr_b16 v[60:61], v2 offset:53248
v_add_f32 v72, 1.0, v72
s_waitcnt lgkmcnt(9)
v_mfma_f32_16x16x32_bf16 v[28:31], v[40:43], a[80:83], v[28:31]
ds_read_b64_tr_b16 v[62:63], v2 offset:53760
v_add_f32 v73, 1.0, v73
v_add_f32 v74, 1.0, v74
v_add_f32 v75, 1.0, v75
s_waitcnt lgkmcnt(8)
v_mfma_f32_16x16x32_bf16 v[28:31], v[44:47], a[88:91], v[28:31]
s_add_u32 m0, s34, 131072
s_add_u32 s35, s61, s78
buffer_load_dwordx4 v8, s[8:11], s35 offen  lds
ds_read_b64_tr_b16 v[64:65], v2 offset:57344
v_add_f32 v76, 1.0, v76
v_add_f32 v77, 1.0, v77
v_mfma_f32_16x16x32_bf16 v[32:35], v[36:39], a[76:79], v[32:35]
ds_read_b64_tr_b16 v[66:67], v2 offset:57856
v_add_f32 v78, 1.0, v78
v_add_f32 v79, 1.0, v79
v_mfma_f32_16x16x32_bf16 v[32:35], v[40:43], a[84:87], v[32:35]
s_add_u32 m0, s34, 139264
s_add_u32 s35, s62, s78
buffer_load_dwordx4 v8, s[8:11], s35 offen  lds
ds_read_b64_tr_b16 v[68:69], v2 offset:61440
v_rcp_f32 v72, v72
v_mfma_f32_16x16x32_bf16 v[32:35], v[44:47], a[92:95], v[32:35]
ds_read_b64_tr_b16 v[70:71], v2 offset:61952
v_rcp_f32 v73, v73
s_waitcnt vmcnt(9)
s_barrier
s_waitcnt lgkmcnt(10)
v_mfma_f32_16x16x32_bf16 v[28:31], v[48:51], a[96:99], v[28:31]
ds_read_b64_tr_b16 v[36:37], v3 offset:0
v_rcp_f32 v74, v74
s_waitcnt lgkmcnt(9)
v_mfma_f32_16x16x32_bf16 v[28:31], v[52:55], a[104:107], v[28:31]
s_add_u32 m0, s34, 16384
s_add_u32 s35, s63, s78
buffer_load_dwordx4 v8, s[8:11], s35 offen  lds
ds_read_b64_tr_b16 v[38:39], v3 offset:512
v_rcp_f32 v75, v75
s_waitcnt lgkmcnt(8)
v_mfma_f32_16x16x32_bf16 v[28:31], v[56:59], a[112:115], v[28:31]
ds_read_b64_tr_b16 v[40:41], v3 offset:4096
v_rcp_f32 v76, v76
v_mfma_f32_16x16x32_bf16 v[32:35], v[48:51], a[100:103], v[32:35]
ds_read_b64_tr_b16 v[42:43], v3 offset:4608
v_rcp_f32 v77, v77
v_mfma_f32_16x16x32_bf16 v[32:35], v[52:55], a[108:111], v[32:35]
s_add_u32 m0, s34, 24576
s_add_u32 s35, s64, s78
buffer_load_dwordx4 v8, s[8:11], s35 offen  lds
ds_read_b64_tr_b16 v[44:45], v3 offset:8192
v_rcp_f32 v78, v78
v_mfma_f32_16x16x32_bf16 v[32:35], v[56:59], a[116:119], v[32:35]
ds_read_b64_tr_b16 v[46:47], v3 offset:8704
s_add_u32 s79, s79, 256
s_cmp_eq_u32 s79, 2304
s_cselect_b32 s79, 0, s79
v_add_u32 v80, s79, v15
ds_read_b128 v[80:83], v80
v_rcp_f32 v79, v79
s_waitcnt lgkmcnt(11)
v_mfma_f32_16x16x32_bf16 v[28:31], v[60:63], a[120:123], v[28:31]
ds_read_b64_tr_b16 v[48:49], v3 offset:12288
v_mul_f32 v72, v20, v72
v_mul_f32 v73, v21, v73
s_waitcnt lgkmcnt(10)
v_mfma_f32_16x16x32_bf16 v[28:31], v[64:67], a[128:131], v[28:31]
s_add_u32 m0, s34, 32768
s_add_u32 s35, s65, s78
buffer_load_dwordx4 v8, s[8:11], s35 offen  lds
ds_read_b64_tr_b16 v[50:51], v3 offset:12800
v_mul_f32 v74, v22, v74
v_mul_f32 v75, v23, v75
s_waitcnt lgkmcnt(9)
v_mfma_f32_16x16x32_bf16 v[28:31], v[68:71], a[136:139], v[28:31]
ds_read_b64_tr_b16 v[52:53], v3 offset:16384
v_mul_f32 v76, v24, v76
v_mul_f32 v77, v25, v77
v_mfma_f32_16x16x32_bf16 v[32:35], v[60:63], a[124:127], v[32:35]
ds_read_b64_tr_b16 v[54:55], v3 offset:16896
v_mul_f32 v78, v26, v78
v_mul_f32 v79, v27, v79
v_mfma_f32_16x16x32_bf16 v[32:35], v[64:67], a[132:135], v[32:35]
s_add_u32 m0, s34, 147456
s_add_u32 s35, s66, s78
buffer_load_dwordx4 v8, s[8:11], s35 offen  lds
ds_read_b64_tr_b16 v[56:57], v3 offset:20480
v_cvt_pk_bf16_f32 v84, v72, v73
v_cvt_pk_bf16_f32 v85, v74, v75
v_mfma_f32_16x16x32_bf16 v[32:35], v[68:71], a[140:143], v[32:35]
ds_read_b64_tr_b16 v[58:59], v3 offset:20992
v_cvt_pk_bf16_f32 v86, v76, v77
v_cvt_pk_bf16_f32 v87, v78, v79
s_waitcnt vmcnt(10)
s_barrier
s_waitcnt lgkmcnt(6)
v_mfma_f32_16x16x32_bf16 v[20:23], v[36:39], a[0:3], v[80:83]
ds_read_b64_tr_b16 v[60:61], v3 offset:24576
v_mfma_f32_16x16x32_bf16 v[20:23], v[40:43], a[8:11], v[20:23]
s_add_u32 m0, s34, 40960
s_add_u32 s35, s67, s78
buffer_load_dwordx4 v8, s[8:11], s35 offen  lds
ds_read_b64_tr_b16 v[62:63], v3 offset:25088
v_mfma_f32_16x16x32_bf16 v[20:23], v[44:47], a[16:19], v[20:23]
ds_read_b64_tr_b16 v[64:65], v3 offset:28672
v_mfma_f32_16x16x32_bf16 v[24:27], v[36:39], a[4:7], v[80:83]
ds_read_b64_tr_b16 v[66:67], v3 offset:29184
v_fma_f32 v72, v28, v28, s40
v_fma_f32 v73, v29, v29, s40
v_fma_f32 v74, v30, v30, s40
v_mfma_f32_16x16x32_bf16 v[24:27], v[40:43], a[12:15], v[24:27]
ds_read_b64_tr_b16 v[68:69], v3 offset:32768
v_fma_f32 v75, v31, v31, s40
v_fma_f32 v76, v32, v32, s40
v_mfma_f32_16x16x32_bf16 v[24:27], v[44:47], a[20:23], v[24:27]
s_add_u32 m0, s34, 49152
s_add_u32 s35, s68, s78
buffer_load_dwordx4 v8, s[8:11], s35 offen  lds
ds_read_b64_tr_b16 v[70:71], v3 offset:33280
v_fma_f32 v77, v33, v33, s40
v_fma_f32 v78, v34, v34, s40
s_waitcnt lgkmcnt(10)
v_mfma_f32_16x16x32_bf16 v[20:23], v[48:51], a[24:27], v[20:23]
ds_read_b64_tr_b16 v[36:37], v3 offset:36864
v_fma_f32 v79, v35, v35, s40
v_mul_f32 v72, v28, v72
s_waitcnt lgkmcnt(9)
v_mfma_f32_16x16x32_bf16 v[20:23], v[52:55], a[32:35], v[20:23]
ds_read_b64_tr_b16 v[38:39], v3 offset:37376
v_mul_f32 v73, v29, v73
v_mul_f32 v74, v30, v74
s_waitcnt lgkmcnt(8)
v_mfma_f32_16x16x32_bf16 v[20:23], v[56:59], a[40:43], v[20:23]
ds_read_b64_tr_b16 v[40:41], v3 offset:40960
v_mul_f32 v75, v31, v75
v_mul_f32 v76, v32, v76
v_mfma_f32_16x16x32_bf16 v[24:27], v[48:51], a[28:31], v[24:27]
s_add_u32 s78, s78, 128
s_cmp_eq_u32 s78, 1152
s_cselect_b32 s78, 0, s78
s_add_u32 m0, s34, 57344
s_add_u32 s35, s60, s78
buffer_load_dwordx4 v8, s[8:11], s35 offen  lds
ds_read_b64_tr_b16 v[42:43], v3 offset:41472
v_mul_f32 v77, v33, v77
v_mul_f32 v78, v34, v78
v_mfma_f32_16x16x32_bf16 v[24:27], v[52:55], a[36:39], v[24:27]
ds_read_b64_tr_b16 v[44:45], v3 offset:45056
v_mul_f32 v79, v35, v79
v_exp_f32 v72, v72
v_mfma_f32_16x16x32_bf16 v[24:27], v[56:59], a[44:47], v[24:27]
ds_read_b64_tr_b16 v[46:47], v3 offset:45568
v_exp_f32 v73, v73
s_waitcnt vmcnt(10)
s_barrier
s_lshr_b32 s36, s24, 0
s_cmp_lg_u32 s36, 3
s_cbranch_scc1 standalone__mixer_channel_mlp__prompt_kernel_nopf3
buffer_load_dword v0, v0, s[8:11], 0 offen
standalone__mixer_channel_mlp__prompt_kernel_nopf3:
s_lshr_b32 s36, s24, 0
s_cmp_lg_u32 s36, 4
s_cbranch_scc1 standalone__mixer_channel_mlp__prompt_kernel_nopf4
buffer_load_dword v0, v0, s[8:11], 0 offen
standalone__mixer_channel_mlp__prompt_kernel_nopf4:
s_lshr_b32 s36, s24, 0
s_cmp_lg_u32 s36, 5
s_cbranch_scc1 standalone__mixer_channel_mlp__prompt_kernel_nopf5
buffer_load_dword v0, v0, s[8:11], 0 offen
standalone__mixer_channel_mlp__prompt_kernel_nopf5:
s_lshr_b32 s36, s24, 0
s_cmp_lg_u32 s36, 0
s_cbranch_scc1 standalone__mixer_channel_mlp__prompt_kernel_nopf6
buffer_load_dword v1, v1, s[12:15], 0 offen
standalone__mixer_channel_mlp__prompt_kernel_nopf6:
s_waitcnt lgkmcnt(10)
v_mfma_f32_16x16x32_bf16 v[20:23], v[60:63], a[48:51], v[20:23]
ds_read_b64_tr_b16 v[48:49], v3 offset:49152
v_exp_f32 v74, v74
s_waitcnt lgkmcnt(9)
v_mfma_f32_16x16x32_bf16 v[20:23], v[64:67], a[56:59], v[20:23]
ds_read_b64_tr_b16 v[50:51], v3 offset:49664
v_exp_f32 v75, v75
s_waitcnt lgkmcnt(8)
v_mfma_f32_16x16x32_bf16 v[20:23], v[68:71], a[64:67], v[20:23]
ds_read_b64_tr_b16 v[52:53], v3 offset:53248
v_exp_f32 v76, v76
v_mfma_f32_16x16x32_bf16 v[24:27], v[60:63], a[52:55], v[24:27]
ds_read_b64_tr_b16 v[54:55], v3 offset:53760
v_exp_f32 v77, v77
v_mfma_f32_16x16x32_bf16 v[24:27], v[64:67], a[60:63], v[24:27]
ds_read_b64_tr_b16 v[56:57], v2 offset:0
v_exp_f32 v78, v78
v_mfma_f32_16x16x32_bf16 v[24:27], v[68:71], a[68:71], v[24:27]
ds_read_b64_tr_b16 v[58:59], v2 offset:512
v_exp_f32 v79, v79
s_waitcnt lgkmcnt(10)
v_mfma_f32_16x16x32_bf16 v[20:23], v[36:39], a[72:75], v[20:23]
ds_read_b64_tr_b16 v[60:61], v2 offset:4096
v_add_f32 v72, 1.0, v72
s_waitcnt lgkmcnt(9)
v_mfma_f32_16x16x32_bf16 v[20:23], v[40:43], a[80:83], v[20:23]
ds_read_b64_tr_b16 v[62:63], v2 offset:4608
v_add_f32 v73, 1.0, v73
v_add_f32 v74, 1.0, v74
v_add_f32 v75, 1.0, v75
s_waitcnt lgkmcnt(8)
v_mfma_f32_16x16x32_bf16 v[20:23], v[44:47], a[88:91], v[20:23]
ds_read_b64_tr_b16 v[64:65], v2 offset:8192
v_add_f32 v76, 1.0, v76
v_add_f32 v77, 1.0, v77
v_mfma_f32_16x16x32_bf16 v[24:27], v[36:39], a[76:79], v[24:27]
ds_read_b64_tr_b16 v[66:67], v2 offset:8704
v_add_f32 v78, 1.0, v78
v_add_f32 v79, 1.0, v79
v_mfma_f32_16x16x32_bf16 v[24:27], v[40:43], a[84:87], v[24:27]
ds_read_b64_tr_b16 v[68:69], v2 offset:12288
v_rcp_f32 v72, v72
v_mfma_f32_16x16x32_bf16 v[24:27], v[44:47], a[92:95], v[24:27]
ds_read_b64_tr_b16 v[70:71], v2 offset:12800
v_rcp_f32 v73, v73
s_waitcnt vmcnt(7)
s_barrier
s_waitcnt lgkmcnt(10)
v_mfma_f32_16x16x32_bf16 v[20:23], v[48:51], a[96:99], v[20:23]
ds_read_b64_tr_b16 v[36:37], v3 offset:57344
v_rcp_f32 v74, v74
s_waitcnt lgkmcnt(9)
v_mfma_f32_16x16x32_bf16 v[20:23], v[52:55], a[104:107], v[20:23]
ds_read_b64_tr_b16 v[38:39], v3 offset:57856
v_rcp_f32 v75, v75
s_waitcnt lgkmcnt(8)
v_mfma_f32_16x16x32_bf16 v[20:23], v[56:59], a[112:115], v[20:23]
ds_read_b64_tr_b16 v[40:41], v3 offset:61440
v_rcp_f32 v76, v76
v_mfma_f32_16x16x32_bf16 v[24:27], v[48:51], a[100:103], v[24:27]
ds_read_b64_tr_b16 v[42:43], v3 offset:61952
v_rcp_f32 v77, v77
v_mfma_f32_16x16x32_bf16 v[24:27], v[52:55], a[108:111], v[24:27]
ds_read_b64_tr_b16 v[44:45], v4 offset:0
v_rcp_f32 v78, v78
v_mfma_f32_16x16x32_bf16 v[24:27], v[56:59], a[116:119], v[24:27]
ds_read_b64_tr_b16 v[46:47], v4 offset:512
s_add_u32 s79, s79, 256
s_cmp_eq_u32 s79, 2304
s_cselect_b32 s79, 0, s79
v_add_u32 v80, s79, v15
ds_read_b128 v[80:83], v80
v_rcp_f32 v79, v79
s_waitcnt lgkmcnt(11)
v_mfma_f32_16x16x32_bf16 v[20:23], v[60:63], a[120:123], v[20:23]
ds_read_b64_tr_b16 v[48:49], v4 offset:4096
v_mul_f32 v72, v28, v72
v_mul_f32 v73, v29, v73
s_waitcnt lgkmcnt(10)
v_mfma_f32_16x16x32_bf16 v[20:23], v[64:67], a[128:131], v[20:23]
ds_read_b64_tr_b16 v[50:51], v4 offset:4608
v_mul_f32 v74, v30, v74
v_mul_f32 v75, v31, v75
s_waitcnt lgkmcnt(9)
v_mfma_f32_16x16x32_bf16 v[20:23], v[68:71], a[136:139], v[20:23]
ds_read_b64_tr_b16 v[52:53], v4 offset:8192
v_mul_f32 v76, v32, v76
v_mul_f32 v77, v33, v77
v_mfma_f32_16x16x32_bf16 v[24:27], v[60:63], a[124:127], v[24:27]
ds_read_b64_tr_b16 v[54:55], v4 offset:8704
v_mul_f32 v78, v34, v78
v_mul_f32 v79, v35, v79
v_mfma_f32_16x16x32_bf16 v[24:27], v[64:67], a[132:135], v[24:27]
ds_read_b64_tr_b16 v[56:57], v4 offset:12288
v_cvt_pk_bf16_f32 v88, v72, v73
v_cvt_pk_bf16_f32 v89, v74, v75
v_mfma_f32_16x16x32_bf16 v[24:27], v[68:71], a[140:143], v[24:27]
ds_read_b64_tr_b16 v[58:59], v4 offset:12800
v_cvt_pk_bf16_f32 v90, v76, v77
v_cvt_pk_bf16_f32 v91, v78, v79
s_waitcnt vmcnt(4)
s_barrier
s_waitcnt lgkmcnt(6)
v_mfma_f32_16x16x32_bf16 v[28:31], v[36:39], a[0:3], v[80:83]
ds_read_b64_tr_b16 v[60:61], v2 offset:16384
v_mfma_f32_16x16x32_bf16 v[28:31], v[40:43], a[8:11], v[28:31]
s_add_u32 m0, s34, 0
s_add_u32 s35, s61, s78
buffer_load_dwordx4 v8, s[8:11], s35 offen  lds
ds_read_b64_tr_b16 v[62:63], v2 offset:16896
v_mfma_f32_16x16x32_bf16 v[28:31], v[44:47], a[16:19], v[28:31]
ds_read_b64_tr_b16 v[64:65], v2 offset:20480
v_mfma_f32_16x16x32_bf16 v[32:35], v[36:39], a[4:7], v[80:83]
s_add_u32 m0, s34, 8192
s_add_u32 s35, s62, s78
buffer_load_dwordx4 v8, s[8:11], s35 offen  lds
ds_read_b64_tr_b16 v[66:67], v2 offset:20992
v_fma_f32 v72, v20, v20, s40
v_fma_f32 v73, v21, v21, s40
v_fma_f32 v74, v22, v22, s40
v_mfma_f32_16x16x32_bf16 v[32:35], v[40:43], a[12:15], v[32:35]
ds_read_b64_tr_b16 v[68:69], v2 offset:24576
v_fma_f32 v75, v23, v23, s40
v_fma_f32 v76, v24, v24, s40
v_mfma_f32_16x16x32_bf16 v[32:35], v[44:47], a[20:23], v[32:35]
s_add_u32 m0, s34, 65536
s_add_u32 s35, s63, s78
buffer_load_dwordx4 v8, s[8:11], s35 offen  lds
ds_read_b64_tr_b16 v[70:71], v2 offset:25088
v_fma_f32 v77, v25, v25, s40
v_fma_f32 v78, v26, v26, s40
s_waitcnt lgkmcnt(10)
v_mfma_f32_16x16x32_bf16 v[28:31], v[48:51], a[24:27], v[28:31]
ds_read_b64_tr_b16 v[36:37], v2 offset:28672
v_fma_f32 v79, v27, v27, s40
v_mul_f32 v72, v20, v72
s_waitcnt lgkmcnt(9)
v_mfma_f32_16x16x32_bf16 v[28:31], v[52:55], a[32:35], v[28:31]
ds_read_b64_tr_b16 v[38:39], v2 offset:29184
v_mul_f32 v73, v21, v73
v_mul_f32 v74, v22, v74
s_waitcnt lgkmcnt(8)
v_mfma_f32_16x16x32_bf16 v[28:31], v[56:59], a[40:43], v[28:31]
s_add_u32 m0, s34, 73728
s_add_u32 s35, s64, s78
buffer_load_dwordx4 v8, s[8:11], s35 offen  lds
ds_read_b64_tr_b16 v[40:41], v2 offset:32768
v_mul_f32 v75, v23, v75
v_mul_f32 v76, v24, v76
v_mfma_f32_16x16x32_bf16 v[32:35], v[48:51], a[28:31], v[32:35]
ds_read_b64_tr_b16 v[42:43], v2 offset:33280
v_mul_f32 v77, v25, v77
v_mul_f32 v78, v26, v78
v_mfma_f32_16x16x32_bf16 v[32:35], v[52:55], a[36:39], v[32:35]
s_add_u32 m0, s34, 81920
s_add_u32 s35, s65, s78
buffer_load_dwordx4 v8, s[8:11], s35 offen  lds
ds_read_b64_tr_b16 v[44:45], v2 offset:36864
v_mul_f32 v79, v27, v79
v_exp_f32 v72, v72
v_mfma_f32_16x16x32_bf16 v[32:35], v[56:59], a[44:47], v[32:35]
ds_read_b64_tr_b16 v[46:47], v2 offset:37376
v_exp_f32 v73, v73
s_waitcnt vmcnt(6)
s_barrier
s_waitcnt lgkmcnt(10)
v_mfma_f32_16x16x32_bf16 v[28:31], v[60:63], a[48:51], v[28:31]
ds_read_b64_tr_b16 v[48:49], v4 offset:16384
v_exp_f32 v74, v74
s_waitcnt lgkmcnt(9)
v_mfma_f32_16x16x32_bf16 v[28:31], v[64:67], a[56:59], v[28:31]
s_add_u32 m0, s34, 90112
s_add_u32 s35, s66, s78
buffer_load_dwordx4 v8, s[8:11], s35 offen  lds
ds_read_b64_tr_b16 v[50:51], v4 offset:16896
v_exp_f32 v75, v75
s_waitcnt lgkmcnt(8)
v_mfma_f32_16x16x32_bf16 v[28:31], v[68:71], a[64:67], v[28:31]
ds_read_b64_tr_b16 v[52:53], v4 offset:20480
v_exp_f32 v76, v76
v_mfma_f32_16x16x32_bf16 v[32:35], v[60:63], a[52:55], v[32:35]
s_add_u32 m0, s34, 98304
s_add_u32 s35, s67, s78
buffer_load_dwordx4 v8, s[8:11], s35 offen  lds
ds_read_b64_tr_b16 v[54:55], v4 offset:20992
v_exp_f32 v77, v77
v_mfma_f32_16x16x32_bf16 v[32:35], v[64:67], a[60:63], v[32:35]
ds_read_b64_tr_b16 v[56:57], v2 offset:40960
v_exp_f32 v78, v78
v_mfma_f32_16x16x32_bf16 v[32:35], v[68:71], a[68:71], v[32:35]
s_add_u32 m0, s34, 106496
s_add_u32 s35, s68, s78
buffer_load_dwordx4 v8, s[8:11], s35 offen  lds
ds_read_b64_tr_b16 v[58:59], v2 offset:41472
v_exp_f32 v79, v79
s_waitcnt lgkmcnt(10)
v_mfma_f32_16x16x32_bf16 v[28:31], v[36:39], a[72:75], v[28:31]
ds_read_b64_tr_b16 v[60:61], v2 offset:45056
v_add_f32 v72, 1.0, v72
s_waitcnt lgkmcnt(9)
v_mfma_f32_16x16x32_bf16 v[28:31], v[40:43], a[80:83], v[28:31]
ds_read_b64_tr_b16 v[62:63], v2 offset:45568
v_add_f32 v73, 1.0, v73
v_add_f32 v74, 1.0, v74
v_add_f32 v75, 1.0, v75
s_waitcnt lgkmcnt(8)
v_mfma_f32_16x16x32_bf16 v[28:31], v[44:47], a[88:91], v[28:31]
s_add_u32 s78, s78, 128
s_cmp_eq_u32 s78, 1152
s_cselect_b32 s78, 0, s78
s_add_u32 m0, s34, 114688
s_add_u32 s35, s60, s78
buffer_load_dwordx4 v8, s[8:11], s35 offen  lds
ds_read_b64_tr_b16 v[64:65], v2 offset:49152
v_add_f32 v76, 1.0, v76
v_add_f32 v77, 1.0, v77
v_mfma_f32_16x16x32_bf16 v[32:35], v[36:39], a[76:79], v[32:35]
ds_read_b64_tr_b16 v[66:67], v2 offset:49664
v_add_f32 v78, 1.0, v78
v_add_f32 v79, 1.0, v79
v_mfma_f32_16x16x32_bf16 v[32:35], v[40:43], a[84:87], v[32:35]
s_add_u32 m0, s34, 122880
s_add_u32 s35, s61, s78
buffer_load_dwordx4 v8, s[8:11], s35 offen  lds
ds_read_b64_tr_b16 v[68:69], v2 offset:53248
v_rcp_f32 v72, v72
v_mfma_f32_16x16x32_bf16 v[32:35], v[44:47], a[92:95], v[32:35]
ds_read_b64_tr_b16 v[70:71], v2 offset:53760
v_rcp_f32 v73, v73
s_waitcnt vmcnt(8)
s_barrier
s_waitcnt lgkmcnt(10)
v_mfma_f32_16x16x32_bf16 v[28:31], v[48:51], a[96:99], v[28:31]
ds_read_b64_tr_b16 v[36:37], v2 offset:57344
v_rcp_f32 v74, v74
s_waitcnt lgkmcnt(9)
v_mfma_f32_16x16x32_bf16 v[28:31], v[52:55], a[104:107], v[28:31]
s_add_u32 m0, s34, 16384
s_add_u32 s35, s62, s78
buffer_load_dwordx4 v8, s[8:11], s35 offen  lds
ds_read_b64_tr_b16 v[38:39], v2 offset:57856
v_rcp_f32 v75, v75
s_waitcnt lgkmcnt(8)
v_mfma_f32_16x16x32_bf16 v[28:31], v[56:59], a[112:115], v[28:31]
ds_read_b64_tr_b16 v[40:41], v2 offset:61440
v_rcp_f32 v76, v76
v_mfma_f32_16x16x32_bf16 v[32:35], v[48:51], a[100:103], v[32:35]
s_add_u32 m0, s34, 24576
s_add_u32 s35, s63, s78
buffer_load_dwordx4 v8, s[8:11], s35 offen  lds
ds_read_b64_tr_b16 v[42:43], v2 offset:61952
v_rcp_f32 v77, v77
v_mfma_f32_16x16x32_bf16 v[32:35], v[52:55], a[108:111], v[32:35]
ds_read_b64_tr_b16 v[44:45], v2 offset:0
v_rcp_f32 v78, v78
v_mfma_f32_16x16x32_bf16 v[32:35], v[56:59], a[116:119], v[32:35]
s_add_u32 m0, s34, 32768
s_add_u32 s35, s64, s78
buffer_load_dwordx4 v8, s[8:11], s35 offen  lds
ds_read_b64_tr_b16 v[46:47], v2 offset:512
s_add_u32 s79, s79, 256
s_cmp_eq_u32 s79, 2304
s_cselect_b32 s79, 0, s79
v_add_u32 v80, s79, v15
ds_read_b128 v[80:83], v80
v_rcp_f32 v79, v79
s_waitcnt lgkmcnt(11)
v_mfma_f32_16x16x32_bf16 v[28:31], v[60:63], a[120:123], v[28:31]
ds_read_b64_tr_b16 v[48:49], v2 offset:4096
v_mul_f32 v72, v20, v72
v_mul_f32 v73, v21, v73
s_waitcnt lgkmcnt(10)
v_mfma_f32_16x16x32_bf16 v[28:31], v[64:67], a[128:131], v[28:31]
ds_read_b64_tr_b16 v[50:51], v2 offset:4608
v_mul_f32 v74, v22, v74
v_mul_f32 v75, v23, v75
s_waitcnt lgkmcnt(9)
v_mfma_f32_16x16x32_bf16 v[28:31], v[68:71], a[136:139], v[28:31]
s_add_u32 m0, s34, 131072
s_add_u32 s35, s65, s78
buffer_load_dwordx4 v8, s[8:11], s35 offen  lds
ds_read_b64_tr_b16 v[52:53], v2 offset:8192
v_mul_f32 v76, v24, v76
v_mul_f32 v77, v25, v77
v_mfma_f32_16x16x32_bf16 v[32:35], v[60:63], a[124:127], v[32:35]
ds_read_b64_tr_b16 v[54:55], v2 offset:8704
v_mul_f32 v78, v26, v78
v_mul_f32 v79, v27, v79
v_mfma_f32_16x16x32_bf16 v[32:35], v[64:67], a[132:135], v[32:35]
s_add_u32 m0, s34, 139264
s_add_u32 s35, s66, s78
buffer_load_dwordx4 v8, s[8:11], s35 offen  lds
ds_read_b64_tr_b16 v[56:57], v2 offset:12288
v_cvt_pk_bf16_f32 v92, v72, v73
v_cvt_pk_bf16_f32 v93, v74, v75
v_mfma_f32_16x16x32_bf16 v[32:35], v[68:71], a[140:143], v[32:35]
ds_read_b64_tr_b16 v[58:59], v2 offset:12800
v_cvt_pk_bf16_f32 v94, v76, v77
v_cvt_pk_bf16_f32 v95, v78, v79
s_waitcnt vmcnt(10)
s_barrier
s_lshr_b32 s36, s24, 0
s_cmp_lg_u32 s36, 1
s_cbranch_scc1 standalone__mixer_channel_mlp__prompt_kernel_nopf7
buffer_load_dword v1, v1, s[12:15], 0 offen
standalone__mixer_channel_mlp__prompt_kernel_nopf7:
s_lshr_b32 s36, s24, 0
s_cmp_lg_u32 s36, 2
s_cbranch_scc1 standalone__mixer_channel_mlp__prompt_kernel_nopf8
buffer_load_dword v1, v1, s[12:15], 0 offen
standalone__mixer_channel_mlp__prompt_kernel_nopf8:
s_lshr_b32 s36, s24, 0
s_cmp_lg_u32 s36, 3
s_cbranch_scc1 standalone__mixer_channel_mlp__prompt_kernel_nopf9
buffer_load_dword v1, v1, s[12:15], 0 offen
standalone__mixer_channel_mlp__prompt_kernel_nopf9:
s_lshl_b32 s36, s26, 2
v_mov_b32 v13, s36
global_load_dword v13, v13, s[56:57] sc1
s_waitcnt lgkmcnt(6)
v_mfma_f32_16x16x32_bf16 v[20:23], v[36:39], a[0:3], v[80:83]
ds_read_b64_tr_b16 v[60:61], v3 offset:0
v_mfma_f32_16x16x32_bf16 v[20:23], v[40:43], a[8:11], v[20:23]
ds_read_b64_tr_b16 v[62:63], v3 offset:512
v_mfma_f32_16x16x32_bf16 v[20:23], v[44:47], a[16:19], v[20:23]
ds_read_b64_tr_b16 v[64:65], v3 offset:4096
v_mfma_f32_16x16x32_bf16 v[24:27], v[36:39], a[4:7], v[80:83]
ds_read_b64_tr_b16 v[66:67], v3 offset:4608
v_fma_f32 v72, v28, v28, s40
v_fma_f32 v73, v29, v29, s40
v_fma_f32 v74, v30, v30, s40
v_mfma_f32_16x16x32_bf16 v[24:27], v[40:43], a[12:15], v[24:27]
ds_read_b64_tr_b16 v[68:69], v3 offset:8192
v_fma_f32 v75, v31, v31, s40
v_fma_f32 v76, v32, v32, s40
v_mfma_f32_16x16x32_bf16 v[24:27], v[44:47], a[20:23], v[24:27]
ds_read_b64_tr_b16 v[70:71], v3 offset:8704
v_fma_f32 v77, v33, v33, s40
v_fma_f32 v78, v34, v34, s40
s_waitcnt lgkmcnt(10)
v_mfma_f32_16x16x32_bf16 v[20:23], v[48:51], a[24:27], v[20:23]
ds_read_b64_tr_b16 v[36:37], v3 offset:12288
v_fma_f32 v79, v35, v35, s40
v_mul_f32 v72, v28, v72
s_waitcnt lgkmcnt(9)
v_mfma_f32_16x16x32_bf16 v[20:23], v[52:55], a[32:35], v[20:23]
ds_read_b64_tr_b16 v[38:39], v3 offset:12800
v_mul_f32 v73, v29, v73
v_mul_f32 v74, v30, v74
s_waitcnt lgkmcnt(8)
v_mfma_f32_16x16x32_bf16 v[20:23], v[56:59], a[40:43], v[20:23]
ds_read_b64_tr_b16 v[40:41], v3 offset:16384
v_mul_f32 v75, v31, v75
v_mul_f32 v76, v32, v76
v_mfma_f32_16x16x32_bf16 v[24:27], v[48:51], a[28:31], v[24:27]
ds_read_b64_tr_b16 v[42:43], v3 offset:16896
v_mul_f32 v77, v33, v77
v_mul_f32 v78, v34, v78
v_mfma_f32_16x16x32_bf16 v[24:27], v[52:55], a[36:39], v[24:27]
ds_read_b64_tr_b16 v[44:45], v3 offset:20480
v_mul_f32 v79, v35, v79
v_exp_f32 v72, v72
v_mfma_f32_16x16x32_bf16 v[24:27], v[56:59], a[44:47], v[24:27]
ds_read_b64_tr_b16 v[46:47], v3 offset:20992
v_exp_f32 v73, v73
s_waitcnt vmcnt(8)
s_barrier
s_waitcnt lgkmcnt(10)
v_mfma_f32_16x16x32_bf16 v[20:23], v[60:63], a[48:51], v[20:23]
ds_read_b64_tr_b16 v[48:49], v3 offset:24576
v_exp_f32 v74, v74
s_waitcnt lgkmcnt(9)
v_mfma_f32_16x16x32_bf16 v[20:23], v[64:67], a[56:59], v[20:23]
ds_read_b64_tr_b16 v[50:51], v3 offset:25088
v_exp_f32 v75, v75
s_waitcnt lgkmcnt(8)
v_mfma_f32_16x16x32_bf16 v[20:23], v[68:71], a[64:67], v[20:23]
ds_read_b64_tr_b16 v[52:53], v3 offset:28672
v_exp_f32 v76, v76
v_mfma_f32_16x16x32_bf16 v[24:27], v[60:63], a[52:55], v[24:27]
ds_read_b64_tr_b16 v[54:55], v3 offset:29184
v_exp_f32 v77, v77
v_mfma_f32_16x16x32_bf16 v[24:27], v[64:67], a[60:63], v[24:27]
ds_read_b64_tr_b16 v[56:57], v3 offset:32768
v_exp_f32 v78, v78
v_mfma_f32_16x16x32_bf16 v[24:27], v[68:71], a[68:71], v[24:27]
ds_read_b64_tr_b16 v[58:59], v3 offset:33280
v_exp_f32 v79, v79
s_waitcnt lgkmcnt(10)
v_mfma_f32_16x16x32_bf16 v[20:23], v[36:39], a[72:75], v[20:23]
ds_read_b64_tr_b16 v[60:61], v3 offset:36864
v_add_f32 v72, 1.0, v72
s_waitcnt lgkmcnt(9)
v_mfma_f32_16x16x32_bf16 v[20:23], v[40:43], a[80:83], v[20:23]
ds_read_b64_tr_b16 v[62:63], v3 offset:37376
v_add_f32 v73, 1.0, v73
v_add_f32 v74, 1.0, v74
v_add_f32 v75, 1.0, v75
s_waitcnt lgkmcnt(8)
v_mfma_f32_16x16x32_bf16 v[20:23], v[44:47], a[88:91], v[20:23]
ds_read_b64_tr_b16 v[64:65], v3 offset:40960
v_add_f32 v76, 1.0, v76
v_add_f32 v77, 1.0, v77
v_mfma_f32_16x16x32_bf16 v[24:27], v[36:39], a[76:79], v[24:27]
ds_read_b64_tr_b16 v[66:67], v3 offset:41472
v_add_f32 v78, 1.0, v78
v_add_f32 v79, 1.0, v79
v_mfma_f32_16x16x32_bf16 v[24:27], v[40:43], a[84:87], v[24:27]
ds_read_b64_tr_b16 v[68:69], v3 offset:45056
v_rcp_f32 v72, v72
v_mfma_f32_16x16x32_bf16 v[24:27], v[44:47], a[92:95], v[24:27]
ds_read_b64_tr_b16 v[70:71], v3 offset:45568
v_rcp_f32 v73, v73
s_waitcnt vmcnt(5)
s_barrier
s_waitcnt lgkmcnt(10)
v_mfma_f32_16x16x32_bf16 v[20:23], v[48:51], a[96:99], v[20:23]
ds_read_b64_tr_b16 v[36:37], v3 offset:49152
v_rcp_f32 v74, v74
s_waitcnt lgkmcnt(9)
v_mfma_f32_16x16x32_bf16 v[20:23], v[52:55], a[104:107], v[20:23]
s_add_u32 m0, s34, 0
s_add_u32 s35, s67, s78
buffer_load_dwordx4 v8, s[8:11], s35 offen  lds
ds_read_b64_tr_b16 v[38:39], v3 offset:49664
v_rcp_f32 v75, v75
s_waitcnt lgkmcnt(8)
v_mfma_f32_16x16x32_bf16 v[20:23], v[56:59], a[112:115], v[20:23]
ds_read_b64_tr_b16 v[40:41], v3 offset:53248
v_rcp_f32 v76, v76
v_mfma_f32_16x16x32_bf16 v[24:27], v[48:51], a[100:103], v[24:27]
s_add_u32 m0, s34, 8192
s_add_u32 s35, s68, s78
buffer_load_dwordx4 v8, s[8:11], s35 offen  lds
ds_read_b64_tr_b16 v[42:43], v3 offset:53760
v_rcp_f32 v77, v77
v_mfma_f32_16x16x32_bf16 v[24:27], v[52:55], a[108:111], v[24:27]
ds_read_b64_tr_b16 v[44:45], v3 offset:57344
v_rcp_f32 v78, v78
v_mfma_f32_16x16x32_bf16 v[24:27], v[56:59], a[116:119], v[24:27]
s_add_u32 s78, s78, 128
s_cmp_eq_u32 s78, 1152
s_cselect_b32 s78, 0, s78
s_add_u32 m0, s34, 40960
s_add_u32 s35, s60, s78
buffer_load_dwordx4 v8, s[8:11], s35 offen  lds
ds_read_b64_tr_b16 v[46:47], v3 offset:57856
s_add_u32 s79, s79, 256
s_cmp_eq_u32 s79, 2304
s_cselect_b32 s79, 0, s79
v_add_u32 v80, s79, v15
ds_read_b128 v[80:83], v80
v_rcp_f32 v79, v79
s_waitcnt lgkmcnt(11)
v_mfma_f32_16x16x32_bf16 v[20:23], v[60:63], a[120:123], v[20:23]
ds_read_b64_tr_b16 v[48:49], v3 offset:61440
v_mul_f32 v72, v28, v72
v_mul_f32 v73, v29, v73
s_waitcnt lgkmcnt(10)
v_mfma_f32_16x16x32_bf16 v[20:23], v[64:67], a[128:131], v[20:23]
ds_read_b64_tr_b16 v[50:51], v3 offset:61952
v_mul_f32 v74, v30, v74
v_mul_f32 v75, v31, v75
s_waitcnt lgkmcnt(9)
v_mfma_f32_16x16x32_bf16 v[20:23], v[68:71], a[136:139], v[20:23]
s_add_u32 m0, s34, 49152
s_add_u32 s35, s61, s78
buffer_load_dwordx4 v8, s[8:11], s35 offen  lds
ds_read_b64_tr_b16 v[52:53], v2 offset:16384
v_mul_f32 v76, v32, v76
v_mul_f32 v77, v33, v77
v_mfma_f32_16x16x32_bf16 v[24:27], v[60:63], a[124:127], v[24:27]
ds_read_b64_tr_b16 v[54:55], v2 offset:16896
v_mul_f32 v78, v34, v78
v_mul_f32 v79, v35, v79
v_mfma_f32_16x16x32_bf16 v[24:27], v[64:67], a[132:135], v[24:27]
s_add_u32 m0, s34, 57344
s_add_u32 s35, s62, s78
buffer_load_dwordx4 v8, s[8:11], s35 offen  lds
ds_read_b64_tr_b16 v[56:57], v2 offset:20480
v_cvt_pk_bf16_f32 v96, v72, v73
v_cvt_pk_bf16_f32 v97, v74, v75
v_mfma_f32_16x16x32_bf16 v[24:27], v[68:71], a[140:143], v[24:27]
ds_read_b64_tr_b16 v[58:59], v2 offset:20992
v_cvt_pk_bf16_f32 v98, v76, v77
v_cvt_pk_bf16_f32 v99, v78, v79
s_waitcnt vmcnt(7)
s_barrier
s_waitcnt lgkmcnt(6)
v_mfma_f32_16x16x32_bf16 v[28:31], v[36:39], a[0:3], v[80:83]
ds_read_b64_tr_b16 v[60:61], v2 offset:24576
v_mfma_f32_16x16x32_bf16 v[28:31], v[40:43], a[8:11], v[28:31]
s_add_u32 m0, s34, 65536
s_add_u32 s35, s63, s78
buffer_load_dwordx4 v8, s[8:11], s35 offen  lds
ds_read_b64_tr_b16 v[62:63], v2 offset:25088
v_mfma_f32_16x16x32_bf16 v[28:31], v[44:47], a[16:19], v[28:31]
ds_read_b64_tr_b16 v[64:65], v2 offset:28672
v_mfma_f32_16x16x32_bf16 v[32:35], v[36:39], a[4:7], v[80:83]
s_add_u32 m0, s34, 73728
s_add_u32 s35, s64, s78
buffer_load_dwordx4 v8, s[8:11], s35 offen  lds
ds_read_b64_tr_b16 v[66:67], v2 offset:29184
v_fma_f32 v72, v20, v20, s40
v_fma_f32 v73, v21, v21, s40
v_fma_f32 v74, v22, v22, s40
v_mfma_f32_16x16x32_bf16 v[32:35], v[40:43], a[12:15], v[32:35]
ds_read_b64_tr_b16 v[68:69], v2 offset:32768
v_fma_f32 v75, v23, v23, s40
v_fma_f32 v76, v24, v24, s40
v_mfma_f32_16x16x32_bf16 v[32:35], v[44:47], a[20:23], v[32:35]
s_add_u32 m0, s34, 81920
s_add_u32 s35, s65, s78
buffer_load_dwordx4 v8, s[8:11], s35 offen  lds
ds_read_b64_tr_b16 v[70:71], v2 offset:33280
v_fma_f32 v77, v25, v25, s40
v_fma_f32 v78, v26, v26, s40
s_waitcnt lgkmcnt(10)
v_mfma_f32_16x16x32_bf16 v[28:31], v[48:51], a[24:27], v[28:31]
ds_read_b64_tr_b16 v[36:37], v2 offset:36864
v_fma_f32 v79, v27, v27, s40
v_mul_f32 v72, v20, v72
s_waitcnt lgkmcnt(9)
v_mfma_f32_16x16x32_bf16 v[28:31], v[52:55], a[32:35], v[28:31]
ds_read_b64_tr_b16 v[38:39], v2 offset:37376
v_mul_f32 v73, v21, v73
v_mul_f32 v74, v22, v74
s_waitcnt lgkmcnt(8)
v_mfma_f32_16x16x32_bf16 v[28:31], v[56:59], a[40:43], v[28:31]
s_add_u32 m0, s34, 90112
s_add_u32 s35, s66, s78
buffer_load_dwordx4 v8, s[8:11], s35 offen  lds
ds_read_b64_tr_b16 v[40:41], v4 offset:0
v_mul_f32 v75, v23, v75
v_mul_f32 v76, v24, v76
v_mfma_f32_16x16x32_bf16 v[32:35], v[48:51], a[28:31], v[32:35]
ds_read_b64_tr_b16 v[42:43], v4 offset:512
v_mul_f32 v77, v25, v77
v_mul_f32 v78, v26, v78
v_mfma_f32_16x16x32_bf16 v[32:35], v[52:55], a[36:39], v[32:35]
s_add_u32 m0, s34, 98304
s_add_u32 s35, s67, s78
buffer_load_dwordx4 v8, s[8:11], s35 offen  lds
ds_read_b64_tr_b16 v[44:45], v4 offset:4096
v_mul_f32 v79, v27, v79
v_exp_f32 v72, v72
v_mfma_f32_16x16x32_bf16 v[32:35], v[56:59], a[44:47], v[32:35]
ds_read_b64_tr_b16 v[46:47], v4 offset:4608
v_exp_f32 v73, v73
s_waitcnt vmcnt(8)
s_barrier
s_waitcnt lgkmcnt(10)
v_mfma_f32_16x16x32_bf16 v[28:31], v[60:63], a[48:51], v[28:31]
ds_read_b64_tr_b16 v[48:49], v4 offset:8192
v_exp_f32 v74, v74
s_waitcnt lgkmcnt(9)
v_mfma_f32_16x16x32_bf16 v[28:31], v[64:67], a[56:59], v[28:31]
s_add_u32 m0, s34, 16384
s_add_u32 s35, s68, s78
buffer_load_dwordx4 v8, s[8:11], s35 offen  lds
ds_read_b64_tr_b16 v[50:51], v4 offset:8704
v_exp_f32 v75, v75
s_waitcnt lgkmcnt(8)
v_mfma_f32_16x16x32_bf16 v[28:31], v[68:71], a[64:67], v[28:31]
ds_read_b64_tr_b16 v[52:53], v4 offset:12288
v_exp_f32 v76, v76
v_mfma_f32_16x16x32_bf16 v[32:35], v[60:63], a[52:55], v[32:35]
s_add_u32 s78, s78, 128
s_cmp_eq_u32 s78, 1152
s_cselect_b32 s78, 0, s78
s_add_u32 m0, s34, 106496
s_add_u32 s35, s60, s78
buffer_load_dwordx4 v8, s[8:11], s35 offen  lds
ds_read_b64_tr_b16 v[54:55], v4 offset:12800
v_exp_f32 v77, v77
v_mfma_f32_16x16x32_bf16 v[32:35], v[64:67], a[60:63], v[32:35]
ds_read_b64_tr_b16 v[56:57], v2 offset:0
v_exp_f32 v78, v78
v_mfma_f32_16x16x32_bf16 v[32:35], v[68:71], a[68:71], v[32:35]
s_add_u32 m0, s34, 114688
s_add_u32 s35, s61, s78
buffer_load_dwordx4 v8, s[8:11], s35 offen  lds
ds_read_b64_tr_b16 v[58:59], v2 offset:512
v_exp_f32 v79, v79
s_waitcnt lgkmcnt(10)
v_mfma_f32_16x16x32_bf16 v[28:31], v[36:39], a[72:75], v[28:31]
ds_read_b64_tr_b16 v[60:61], v2 offset:4096
v_add_f32 v72, 1.0, v72
s_waitcnt lgkmcnt(9)
v_mfma_f32_16x16x32_bf16 v[28:31], v[40:43], a[80:83], v[28:31]
ds_read_b64_tr_b16 v[62:63], v2 offset:4608
v_add_f32 v73, 1.0, v73
v_add_f32 v74, 1.0, v74
v_add_f32 v75, 1.0, v75
s_waitcnt lgkmcnt(8)
v_mfma_f32_16x16x32_bf16 v[28:31], v[44:47], a[88:91], v[28:31]
s_add_u32 m0, s34, 122880
s_add_u32 s35, s62, s78
buffer_load_dwordx4 v8, s[8:11], s35 offen  lds
ds_read_b64_tr_b16 v[64:65], v2 offset:8192
v_add_f32 v76, 1.0, v76
v_add_f32 v77, 1.0, v77
v_mfma_f32_16x16x32_bf16 v[32:35], v[36:39], a[76:79], v[32:35]
ds_read_b64_tr_b16 v[66:67], v2 offset:8704
v_add_f32 v78, 1.0, v78
v_add_f32 v79, 1.0, v79
v_mfma_f32_16x16x32_bf16 v[32:35], v[40:43], a[84:87], v[32:35]
s_add_u32 m0, s34, 147456
s_add_u32 s35, s63, s78
buffer_load_dwordx4 v8, s[8:11], s35 offen  lds
ds_read_b64_tr_b16 v[68:69], v2 offset:12288
v_rcp_f32 v72, v72
v_mfma_f32_16x16x32_bf16 v[32:35], v[44:47], a[92:95], v[32:35]
ds_read_b64_tr_b16 v[70:71], v2 offset:12800
v_rcp_f32 v73, v73
s_waitcnt vmcnt(10)
s_barrier
s_lshr_b32 s36, s24, 0
s_cmp_lg_u32 s36, 4
s_cbranch_scc1 standalone__mixer_channel_mlp__prompt_kernel_nopf10
buffer_load_dword v1, v1, s[12:15], 0 offen
standalone__mixer_channel_mlp__prompt_kernel_nopf10:
s_lshr_b32 s36, s24, 0
s_cmp_lg_u32 s36, 5
s_cbranch_scc1 standalone__mixer_channel_mlp__prompt_kernel_nopf11
buffer_load_dword v1, v1, s[12:15], 0 offen
standalone__mixer_channel_mlp__prompt_kernel_nopf11:
s_waitcnt lgkmcnt(10)
v_mfma_f32_16x16x32_bf16 v[28:31], v[48:51], a[96:99], v[28:31]
ds_read_b64_tr_b16 v[36:37], v2 offset:40960
v_rcp_f32 v74, v74
s_waitcnt lgkmcnt(9)
v_mfma_f32_16x16x32_bf16 v[28:31], v[52:55], a[104:107], v[28:31]
ds_read_b64_tr_b16 v[38:39], v2 offset:41472
v_rcp_f32 v75, v75
s_waitcnt lgkmcnt(8)
v_mfma_f32_16x16x32_bf16 v[28:31], v[56:59], a[112:115], v[28:31]
ds_read_b64_tr_b16 v[40:41], v2 offset:45056
v_rcp_f32 v76, v76
v_mfma_f32_16x16x32_bf16 v[32:35], v[48:51], a[100:103], v[32:35]
ds_read_b64_tr_b16 v[42:43], v2 offset:45568
v_rcp_f32 v77, v77
v_mfma_f32_16x16x32_bf16 v[32:35], v[52:55], a[108:111], v[32:35]
ds_read_b64_tr_b16 v[44:45], v2 offset:49152
v_rcp_f32 v78, v78
v_mfma_f32_16x16x32_bf16 v[32:35], v[56:59], a[116:119], v[32:35]
ds_read_b64_tr_b16 v[46:47], v2 offset:49664
s_add_u32 s79, s79, 256
s_cmp_eq_u32 s79, 2304
s_cselect_b32 s79, 0, s79
v_add_u32 v80, s79, v15
ds_read_b128 v[80:83], v80
v_rcp_f32 v79, v79
s_waitcnt lgkmcnt(11)
v_mfma_f32_16x16x32_bf16 v[28:31], v[60:63], a[120:123], v[28:31]
ds_read_b64_tr_b16 v[48:49], v2 offset:53248
v_mul_f32 v72, v20, v72
v_mul_f32 v73, v21, v73
s_waitcnt lgkmcnt(10)
v_mfma_f32_16x16x32_bf16 v[28:31], v[64:67], a[128:131], v[28:31]
ds_read_b64_tr_b16 v[50:51], v2 offset:53760
v_mul_f32 v74, v22, v74
v_mul_f32 v75, v23, v75
s_waitcnt lgkmcnt(9)
v_mfma_f32_16x16x32_bf16 v[28:31], v[68:71], a[136:139], v[28:31]
ds_read_b64_tr_b16 v[52:53], v2 offset:57344
v_mul_f32 v76, v24, v76
v_mul_f32 v77, v25, v77
v_mfma_f32_16x16x32_bf16 v[32:35], v[60:63], a[124:127], v[32:35]
ds_read_b64_tr_b16 v[54:55], v2 offset:57856
v_mul_f32 v78, v26, v78
v_mul_f32 v79, v27, v79
v_mfma_f32_16x16x32_bf16 v[32:35], v[64:67], a[132:135], v[32:35]
ds_read_b64_tr_b16 v[56:57], v2 offset:61440
v_cvt_pk_bf16_f32 v100, v72, v73
v_cvt_pk_bf16_f32 v101, v74, v75
v_mfma_f32_16x16x32_bf16 v[32:35], v[68:71], a[140:143], v[32:35]
ds_read_b64_tr_b16 v[58:59], v2 offset:61952
v_cvt_pk_bf16_f32 v102, v76, v77
v_cvt_pk_bf16_f32 v103, v78, v79
s_waitcnt vmcnt(7)
s_barrier
s_mov_b32 s39, 0x10000
standalone__mixer_channel_mlp__prompt_kernel_rdy:
v_cmp_eq_u32 vcc, 0, v13
s_and_b64 s[32:33], vcc, exec
s_cbranch_scc0 standalone__mixer_channel_mlp__prompt_kernel_rdy_ok
s_sub_u32 s39, s39, 1
s_cbranch_scc1 standalone__mixer_channel_mlp__prompt_kernel_rdy_ok
s_lshl_b32 s36, s26, 2
v_mov_b32 v13, s36
global_load_dword v13, v13, s[56:57] sc1
s_waitcnt vmcnt(0)
s_branch standalone__mixer_channel_mlp__prompt_kernel_rdy
standalone__mixer_channel_mlp__prompt_kernel_rdy_ok:
s_mov_b32 vcc_lo, s27
s_mov_b32 vcc_hi, 0
s_waitcnt lgkmcnt(6)
v_mfma_f32_16x16x32_bf16 v[20:23], v[36:39], a[0:3], v[80:83]
ds_read_b64_tr_b16 v[60:61], v3 offset:0
v_mov_b32 v108, -1
v_mfma_f32_16x16x32_bf16 v[20:23], v[40:43], a[8:11], v[20:23]
ds_read_b64_tr_b16 v[62:63], v3 offset:512
v_mov_b32 v109, -1
v_mfma_f32_16x16x32_bf16 v[20:23], v[44:47], a[16:19], v[20:23]
ds_read_b64_tr_b16 v[64:65], v3 offset:4096
v_mfma_f32_16x16x32_bf16 v[24:27], v[36:39], a[4:7], v[80:83]
ds_read_b64_tr_b16 v[66:67], v3 offset:4608
v_fma_f32 v72, v28, v28, s40
v_fma_f32 v73, v29, v29, s40
v_fma_f32 v74, v30, v30, s40
v_mov_b32 v110, -1
v_mfma_f32_16x16x32_bf16 v[24:27], v[40:43], a[12:15], v[24:27]
ds_read_b64_tr_b16 v[68:69], v3 offset:8192
v_fma_f32 v75, v31, v31, s40
v_fma_f32 v76, v32, v32, s40
v_mov_b32 v111, -1
v_mfma_f32_16x16x32_bf16 v[24:27], v[44:47], a[20:23], v[24:27]
ds_read_b64_tr_b16 v[70:71], v3 offset:8704
v_fma_f32 v77, v33, v33, s40
v_fma_f32 v78, v34, v34, s40
s_waitcnt lgkmcnt(10)
v_mfma_f32_16x16x32_bf16 v[20:23], v[48:51], a[24:27], v[20:23]
ds_read_b64_tr_b16 v[36:37], v3 offset:12288
v_fma_f32 v79, v35, v35, s40
v_mul_f32 v72, v28, v72
s_mul_i32 s36, s25, 65536
v_subrev_u32 v11, s36, v16
s_waitcnt lgkmcnt(9)
v_mfma_f32_16x16x32_bf16 v[20:23], v[52:55], a[32:35], v[20:23]
ds_read_b64_tr_b16 v[38:39], v3 offset:12800
v_mul_f32 v73, v29, v73
v_mul_f32 v74, v30, v74
s_add_u32 s36, s25, 1
s_and_b32 s36, s36, 7
s_mul_i32 s36, s36, 73728
buffer_store_dwordx4 v[108:111], v11, s[16:19], s36 offen sc1
s_waitcnt lgkmcnt(8)
v_mfma_f32_16x16x32_bf16 v[20:23], v[56:59], a[40:43], v[20:23]
ds_read_b64_tr_b16 v[40:41], v3 offset:16384
v_mul_f32 v75, v31, v75
v_mul_f32 v76, v32, v76
v_mfma_f32_16x16x32_bf16 v[24:27], v[48:51], a[28:31], v[24:27]
ds_read_b64_tr_b16 v[42:43], v3 offset:16896
v_mul_f32 v77, v33, v77
v_mul_f32 v78, v34, v78
v_mfma_f32_16x16x32_bf16 v[24:27], v[52:55], a[36:39], v[24:27]
ds_read_b64_tr_b16 v[44:45], v3 offset:20480
v_mul_f32 v79, v35, v79
v_exp_f32 v72, v72
v_mfma_f32_16x16x32_bf16 v[24:27], v[56:59], a[44:47], v[24:27]
ds_read_b64_tr_b16 v[46:47], v3 offset:20992
v_exp_f32 v73, v73
s_waitcnt vmcnt(5)
s_barrier
s_waitcnt lgkmcnt(10)
v_mfma_f32_16x16x32_bf16 v[20:23], v[60:63], a[48:51], v[20:23]
ds_read_b64_tr_b16 v[48:49], v3 offset:24576
v_exp_f32 v74, v74
s_waitcnt lgkmcnt(9)
v_mfma_f32_16x16x32_bf16 v[20:23], v[64:67], a[56:59], v[20:23]
s_add_u32 m0, s34, 0
s_add_u32 s35, s64, s78
buffer_load_dwordx4 v8, s[8:11], s35 offen  lds
ds_read_b64_tr_b16 v[50:51], v3 offset:25088
v_exp_f32 v75, v75
s_waitcnt lgkmcnt(8)
v_mfma_f32_16x16x32_bf16 v[20:23], v[68:71], a[64:67], v[20:23]
ds_read_b64_tr_b16 v[52:53], v3 offset:28672
v_exp_f32 v76, v76
v_mfma_f32_16x16x32_bf16 v[24:27], v[60:63], a[52:55], v[24:27]
s_add_u32 m0, s34, 8192
s_add_u32 s35, s65, s78
buffer_load_dwordx4 v8, s[8:11], s35 offen  lds
ds_read_b64_tr_b16 v[54:55], v3 offset:29184
v_exp_f32 v77, v77
v_mfma_f32_16x16x32_bf16 v[24:27], v[64:67], a[60:63], v[24:27]
ds_read_b64_tr_b16 v[56:57], v3 offset:32768
v_exp_f32 v78, v78
v_mfma_f32_16x16x32_bf16 v[24:27], v[68:71], a[68:71], v[24:27]
s_add_u32 m0, s34, 24576
s_add_u32 s35, s66, s78
buffer_load_dwordx4 v8, s[8:11], s35 offen  lds
ds_read_b64_tr_b16 v[58:59], v3 offset:33280
v_exp_f32 v79, v79
s_waitcnt lgkmcnt(10)
v_mfma_f32_16x16x32_bf16 v[20:23], v[36:39], a[72:75], v[20:23]
ds_read_b64_tr_b16 v[60:61], v3 offset:36864
v_add_f32 v72, 1.0, v72
s_waitcnt lgkmcnt(9)
v_mfma_f32_16x16x32_bf16 v[20:23], v[40:43], a[80:83], v[20:23]
ds_read_b64_tr_b16 v[62:63], v3 offset:37376
v_add_f32 v73, 1.0, v73
v_add_f32 v74, 1.0, v74
v_add_f32 v75, 1.0, v75
s_waitcnt lgkmcnt(8)
v_mfma_f32_16x16x32_bf16 v[20:23], v[44:47], a[88:91], v[20:23]
s_add_u32 m0, s34, 32768
s_add_u32 s35, s67, s78
buffer_load_dwordx4 v8, s[8:11], s35 offen  lds
ds_read_b64_tr_b16 v[64:65], v2 offset:16384
v_add_f32 v76, 1.0, v76
v_add_f32 v77, 1.0, v77
v_mfma_f32_16x16x32_bf16 v[24:27], v[36:39], a[76:79], v[24:27]
ds_read_b64_tr_b16 v[66:67], v2 offset:16896
v_add_f32 v78, 1.0, v78
v_add_f32 v79, 1.0, v79
v_mfma_f32_16x16x32_bf16 v[24:27], v[40:43], a[84:87], v[24:27]
s_add_u32 m0, s34, 40960
s_add_u32 s35, s68, s78
buffer_load_dwordx4 v8, s[8:11], s35 offen  lds
ds_read_b64_tr_b16 v[68:69], v2 offset:20480
v_rcp_f32 v72, v72
v_mfma_f32_16x16x32_bf16 v[24:27], v[44:47], a[92:95], v[24:27]
ds_read_b64_tr_b16 v[70:71], v2 offset:20992
v_rcp_f32 v73, v73
s_waitcnt vmcnt(7)
s_barrier
s_waitcnt lgkmcnt(10)
v_mfma_f32_16x16x32_bf16 v[20:23], v[48:51], a[96:99], v[20:23]
ds_read_b64_tr_b16 v[36:37], v3 offset:40960
v_rcp_f32 v74, v74
s_waitcnt lgkmcnt(9)
v_mfma_f32_16x16x32_bf16 v[20:23], v[52:55], a[104:107], v[20:23]
s_add_u32 s78, s78, 128
s_cmp_eq_u32 s78, 1152
s_cselect_b32 s78, 0, s78
s_add_u32 m0, s34, 49152
s_add_u32 s35, s60, s78
buffer_load_dwordx4 v8, s[8:11], s35 offen  lds
ds_read_b64_tr_b16 v[38:39], v3 offset:41472
v_rcp_f32 v75, v75
s_waitcnt lgkmcnt(8)
v_mfma_f32_16x16x32_bf16 v[20:23], v[56:59], a[112:115], v[20:23]
ds_read_b64_tr_b16 v[40:41], v3 offset:45056
v_rcp_f32 v76, v76
v_mfma_f32_16x16x32_bf16 v[24:27], v[48:51], a[100:103], v[24:27]
s_add_u32 m0, s34, 57344
s_add_u32 s35, s61, s78
buffer_load_dwordx4 v8, s[8:11], s35 offen  lds
ds_read_b64_tr_b16 v[42:43], v3 offset:45568
v_rcp_f32 v77, v77
v_mfma_f32_16x16x32_bf16 v[24:27], v[52:55], a[108:111], v[24:27]
ds_read_b64_tr_b16 v[44:45], v3 offset:49152
v_rcp_f32 v78, v78
v_mfma_f32_16x16x32_bf16 v[24:27], v[56:59], a[116:119], v[24:27]
s_add_u32 m0, s34, 65536
s_add_u32 s35, s62, s78
buffer_load_dwordx4 v8, s[8:11], s35 offen  lds
ds_read_b64_tr_b16 v[46:47], v3 offset:49664
s_add_u32 s79, s79, 256
s_cmp_eq_u32 s79, 2304
s_cselect_b32 s79, 0, s79
v_add_u32 v80, s79, v15
ds_read_b128 v[80:83], v80
v_rcp_f32 v79, v79
s_waitcnt lgkmcnt(11)
v_mfma_f32_16x16x32_bf16 v[20:23], v[60:63], a[120:123], v[20:23]
ds_read_b64_tr_b16 v[48:49], v3 offset:53248
v_mul_f32 v72, v28, v72
v_mul_f32 v73, v29, v73
s_waitcnt lgkmcnt(10)
v_mfma_f32_16x16x32_bf16 v[20:23], v[64:67], a[128:131], v[20:23]
ds_read_b64_tr_b16 v[50:51], v3 offset:53760
v_mul_f32 v74, v30, v74
v_mul_f32 v75, v31, v75
s_waitcnt lgkmcnt(9)
v_mfma_f32_16x16x32_bf16 v[20:23], v[68:71], a[136:139], v[20:23]
s_add_u32 m0, s34, 73728
s_add_u32 s35, s63, s78
buffer_load_dwordx4 v8, s[8:11], s35 offen  lds
ds_read_b64_tr_b16 v[52:53], v3 offset:57344
v_mul_f32 v76, v32, v76
v_mul_f32 v77, v33, v77
v_mfma_f32_16x16x32_bf16 v[24:27], v[60:63], a[124:127], v[24:27]
ds_read_b64_tr_b16 v[54:55], v3 offset:57856
v_mul_f32 v78, v34, v78
v_mul_f32 v79, v35, v79
v_mfma_f32_16x16x32_bf16 v[24:27], v[64:67], a[132:135], v[24:27]
s_add_u32 m0, s34, 81920
s_add_u32 s35, s64, s78
buffer_load_dwordx4 v8, s[8:11], s35 offen  lds
ds_read_b64_tr_b16 v[56:57], v3 offset:61440
v_cvt_pk_bf16_f32 v104, v72, v73
v_cvt_pk_bf16_f32 v105, v74, v75
v_mfma_f32_16x16x32_bf16 v[24:27], v[68:71], a[140:143], v[24:27]
ds_read_b64_tr_b16 v[58:59], v3 offset:61952
v_cvt_pk_bf16_f32 v106, v76, v77
v_cvt_pk_bf16_f32 v107, v78, v79
s_waitcnt vmcnt(8)
s_barrier
s_waitcnt lgkmcnt(6)
v_mfma_f32_16x16x32_bf16 v[28:31], v[36:39], a[0:3], v[80:83]
ds_read_b64_tr_b16 v[60:61], v4 offset:16384
v_mfma_f32_16x16x32_bf16 v[28:31], v[40:43], a[8:11], v[28:31]
s_add_u32 m0, s34, 16384
s_add_u32 s35, s65, s78
buffer_load_dwordx4 v8, s[8:11], s35 offen  lds
ds_read_b64_tr_b16 v[62:63], v4 offset:16896
v_mfma_f32_16x16x32_bf16 v[28:31], v[44:47], a[16:19], v[28:31]
ds_read_b64_tr_b16 v[64:65], v4 offset:20480
v_mfma_f32_16x16x32_bf16 v[32:35], v[36:39], a[4:7], v[80:83]
s_add_u32 m0, s34, 90112
s_add_u32 s35, s66, s78
buffer_load_dwordx4 v8, s[8:11], s35 offen  lds
ds_read_b64_tr_b16 v[66:67], v4 offset:20992
v_fma_f32 v72, v20, v20, s40
v_fma_f32 v73, v21, v21, s40
v_fma_f32 v74, v22, v22, s40
v_mfma_f32_16x16x32_bf16 v[32:35], v[40:43], a[12:15], v[32:35]
ds_read_b64_tr_b16 v[68:69], v2 offset:0
v_fma_f32 v75, v23, v23, s40
v_fma_f32 v76, v24, v24, s40
v_mfma_f32_16x16x32_bf16 v[32:35], v[44:47], a[20:23], v[32:35]
s_add_u32 m0, s34, 98304
s_add_u32 s35, s67, s78
buffer_load_dwordx4 v8, s[8:11], s35 offen  lds
ds_read_b64_tr_b16 v[70:71], v2 offset:512
v_fma_f32 v77, v25, v25, s40
v_fma_f32 v78, v26, v26, s40
s_waitcnt lgkmcnt(10)
v_mfma_f32_16x16x32_bf16 v[28:31], v[48:51], a[24:27], v[28:31]
ds_read_b64_tr_b16 v[36:37], v2 offset:4096
v_fma_f32 v79, v27, v27, s40
v_mul_f32 v72, v20, v72
s_waitcnt lgkmcnt(9)
v_mfma_f32_16x16x32_bf16 v[28:31], v[52:55], a[32:35], v[28:31]
ds_read_b64_tr_b16 v[38:39], v2 offset:4608
v_mul_f32 v73, v21, v73
v_mul_f32 v74, v22, v74
s_waitcnt lgkmcnt(8)
v_mfma_f32_16x16x32_bf16 v[28:31], v[56:59], a[40:43], v[28:31]
s_add_u32 m0, s34, 131072
s_add_u32 s35, s68, s78
buffer_load_dwordx4 v8, s[8:11], s35 offen  lds
ds_read_b64_tr_b16 v[40:41], v2 offset:8192
v_mul_f32 v75, v23, v75
v_mul_f32 v76, v24, v76
v_mfma_f32_16x16x32_bf16 v[32:35], v[48:51], a[28:31], v[32:35]
ds_read_b64_tr_b16 v[42:43], v2 offset:8704
v_mul_f32 v77, v25, v77
v_mul_f32 v78, v26, v78
v_mfma_f32_16x16x32_bf16 v[32:35], v[52:55], a[36:39], v[32:35]
s_add_u32 m0, s34, 139264
s_add_u32 s35, s69, s80
buffer_load_dwordx4 v9, s[12:15], s35 offen  lds
ds_read_b64_tr_b16 v[44:45], v2 offset:12288
v_mul_f32 v79, v27, v79
v_exp_f32 v72, v72
v_mfma_f32_16x16x32_bf16 v[32:35], v[56:59], a[44:47], v[32:35]
ds_read_b64_tr_b16 v[46:47], v2 offset:12800
v_exp_f32 v73, v73
s_waitcnt vmcnt(10)
s_barrier
s_waitcnt lgkmcnt(10)
v_mfma_f32_16x16x32_bf16 v[28:31], v[60:63], a[48:51], v[28:31]
ds_read_b64_tr_b16 v[48:49], v2 offset:24576
v_exp_f32 v74, v74
s_waitcnt lgkmcnt(9)
v_mfma_f32_16x16x32_bf16 v[28:31], v[64:67], a[56:59], v[28:31]
ds_read_b64_tr_b16 v[50:51], v2 offset:25088
v_exp_f32 v75, v75
v_add_u32 v19, 0x10000, v12
ds_write_b64 v19, v[84:85] offset:40960
s_waitcnt lgkmcnt(9)
v_mfma_f32_16x16x32_bf16 v[28:31], v[68:71], a[64:67], v[28:31]
ds_read_b64_tr_b16 v[52:53], v2 offset:28672
v_exp_f32 v76, v76
v_add_u32 v17, 0x10000, v12
ds_write_b64 v17, v[86:87] offset:41984
v_mfma_f32_16x16x32_bf16 v[32:35], v[60:63], a[52:55], v[32:35]
ds_read_b64_tr_b16 v[54:55], v2 offset:29184
v_exp_f32 v77, v77
v_mfma_f32_16x16x32_bf16 v[32:35], v[64:67], a[60:63], v[32:35]
ds_read_b64_tr_b16 v[56:57], v2 offset:32768
v_exp_f32 v78, v78
v_add_u32 v18, 0x10000, v12
ds_write_b64 v18, v[88:89] offset:49152
v_mfma_f32_16x16x32_bf16 v[32:35], v[68:71], a[68:71], v[32:35]
ds_read_b64_tr_b16 v[58:59], v2 offset:33280
v_exp_f32 v79, v79
s_waitcnt lgkmcnt(13)
v_mfma_f32_16x16x32_bf16 v[28:31], v[36:39], a[72:75], v[28:31]
ds_read_b64_tr_b16 v[60:61], v2 offset:36864
v_add_f32 v72, 1.0, v72
v_add_u32 v19, 0x10000, v12
ds_write_b64 v19, v[90:91] offset:50176
s_waitcnt lgkmcnt(13)
v_mfma_f32_16x16x32_bf16 v[28:31], v[40:43], a[80:83], v[28:31]
ds_read_b64_tr_b16 v[62:63], v2 offset:37376
v_add_f32 v73, 1.0, v73
v_add_f32 v74, 1.0, v74
v_add_f32 v75, 1.0, v75
v_add_u32 v17, 0x10000, v12
ds_write_b64 v17, v[92:93] offset:57344
s_waitcnt lgkmcnt(13)
v_mfma_f32_16x16x32_bf16 v[28:31], v[44:47], a[88:91], v[28:31]
ds_read_b64_tr_b16 v[64:65], v2 offset:40960
v_add_f32 v76, 1.0, v76
v_add_f32 v77, 1.0, v77
v_mfma_f32_16x16x32_bf16 v[32:35], v[36:39], a[76:79], v[32:35]
ds_read_b64_tr_b16 v[66:67], v2 offset:41472
v_add_f32 v78, 1.0, v78
v_add_f32 v79, 1.0, v79
v_add_u32 v18, 0x10000, v12
ds_write_b64 v18, v[94:95] offset:58368
v_mfma_f32_16x16x32_bf16 v[32:35], v[40:43], a[84:87], v[32:35]
ds_read_b64_tr_b16 v[68:69], v2 offset:45056
v_rcp_f32 v72, v72
v_mfma_f32_16x16x32_bf16 v[32:35], v[44:47], a[92:95], v[32:35]
ds_read_b64_tr_b16 v[70:71], v2 offset:45568
v_rcp_f32 v73, v73
s_waitcnt vmcnt(7) lgkmcnt(2)
s_barrier
s_cmp_lg_u32 s24, 0
s_cbranch_scc1 standalone__mixer_channel_mlp__prompt_kernel_nrf
s_add_u32 s36, s25, 1
s_and_b32 s36, s36, 7
s_sub_u32 s39, s36, s25
s_lshl_b32 s39, s39, 2
s_lshl_b32 s36, s36, 8
v_add_u32 v11, s39, v14
s_mov_b64 exec, 1
buffer_store_dword v13, v11, s[16:19], s36 offen sc1
s_mov_b64 exec, -1
standalone__mixer_channel_mlp__prompt_kernel_nrf:
v_mfma_f32_16x16x32_bf16 v[28:31], v[48:51], a[96:99], v[28:31]
ds_read_b64_tr_b16 v[36:37], v2 offset:49152
v_rcp_f32 v74, v74
ds_write_b64 v12, v[96:97] offset:0
v_mfma_f32_16x16x32_bf16 v[28:31], v[52:55], a[104:107], v[28:31]
ds_read_b64_tr_b16 v[38:39], v2 offset:49664
v_rcp_f32 v75, v75
ds_write_b64 v12, v[98:99] offset:1024
v_mfma_f32_16x16x32_bf16 v[28:31], v[56:59], a[112:115], v[28:31]
ds_read_b64_tr_b16 v[40:41], v2 offset:53248
v_rcp_f32 v76, v76
v_mfma_f32_16x16x32_bf16 v[32:35], v[48:51], a[100:103], v[32:35]
ds_read_b64_tr_b16 v[42:43], v2 offset:53760
v_rcp_f32 v77, v77
ds_write_b64 v12, v[100:101] offset:8192
v_mfma_f32_16x16x32_bf16 v[32:35], v[52:55], a[108:111], v[32:35]
ds_read_b64_tr_b16 v[44:45], v2 offset:57344
v_rcp_f32 v78, v78
v_mfma_f32_16x16x32_bf16 v[32:35], v[56:59], a[116:119], v[32:35]
ds_read_b64_tr_b16 v[46:47], v2 offset:57856
s_add_u32 s79, s79, 256
s_cmp_eq_u32 s79, 2304
s_cselect_b32 s79, 0, s79
v_add_u32 v80, s79, v15
ds_read_b128 v[80:83], v80
v_rcp_f32 v79, v79
ds_write_b64 v12, v[102:103] offset:9216
v_mfma_f32_16x16x32_bf16 v[28:31], v[60:63], a[120:123], v[28:31]
ds_read_b64_tr_b16 v[48:49], v2 offset:61440
v_mul_f32 v72, v20, v72
v_mul_f32 v73, v21, v73
v_add_u32 v19, 0x20000, v12
ds_write_b64 v19, v[104:105] offset:16384
v_mfma_f32_16x16x32_bf16 v[28:31], v[64:67], a[128:131], v[28:31]
ds_read_b64_tr_b16 v[50:51], v2 offset:61952
v_mul_f32 v74, v22, v74
v_mul_f32 v75, v23, v75
s_waitcnt lgkmcnt(14)
v_mfma_f32_16x16x32_bf16 v[28:31], v[68:71], a[136:139], v[28:31]
ds_read_b64_tr_b16 v[52:53], v3 offset:0
v_mul_f32 v76, v24, v76
v_mul_f32 v77, v25, v77
v_add_u32 v17, 0x20000, v12
ds_write_b64 v17, v[106:107] offset:17408
v_mfma_f32_16x16x32_bf16 v[32:35], v[60:63], a[124:127], v[32:35]
ds_read_b64_tr_b16 v[54:55], v3 offset:512
v_mul_f32 v78, v26, v78
v_mul_f32 v79, v27, v79
v_mfma_f32_16x16x32_bf16 v[32:35], v[64:67], a[132:135], v[32:35]
ds_read_b64_tr_b16 v[56:57], v3 offset:4096
v_cvt_pk_bf16_f32 v84, v72, v73
v_cvt_pk_bf16_f32 v85, v74, v75
v_mfma_f32_16x16x32_bf16 v[32:35], v[68:71], a[140:143], v[32:35]
ds_read_b64_tr_b16 v[58:59], v3 offset:4608
v_cvt_pk_bf16_f32 v86, v76, v77
v_cvt_pk_bf16_f32 v87, v78, v79
s_waitcnt vmcnt(4) lgkmcnt(3)
s_barrier
v_mfma_f32_16x16x32_bf16 v[20:23], v[36:39], a[0:3], v[80:83]
ds_read_b64_tr_b16 v[60:61], v3 offset:8192
v_mfma_f32_16x16x32_bf16 v[20:23], v[40:43], a[8:11], v[20:23]
s_add_u32 m0, s34, 24576
s_add_u32 s35, s70, s80
buffer_load_dwordx4 v9, s[12:15], s35 offen  lds
ds_read_b64_tr_b16 v[62:63], v3 offset:8704
v_mfma_f32_16x16x32_bf16 v[20:23], v[44:47], a[16:19], v[20:23]
ds_read_b64_tr_b16 v[64:65], v3 offset:12288
v_mfma_f32_16x16x32_bf16 v[24:27], v[36:39], a[4:7], v[80:83]
ds_read_b64_tr_b16 v[66:67], v3 offset:12800
v_fma_f32 v72, v28, v28, s40
v_fma_f32 v73, v29, v29, s40
v_fma_f32 v74, v30, v30, s40
v_mfma_f32_16x16x32_bf16 v[24:27], v[40:43], a[12:15], v[24:27]
ds_read_b64_tr_b16 v[68:69], v3 offset:16384
v_fma_f32 v75, v31, v31, s40
v_fma_f32 v76, v32, v32, s40
v_mfma_f32_16x16x32_bf16 v[24:27], v[44:47], a[20:23], v[24:27]
s_add_u32 m0, s34, 32768
s_add_u32 s35, s71, s80
buffer_load_dwordx4 v9, s[12:15], s35 offen  lds
ds_read_b64_tr_b16 v[70:71], v3 offset:16896
v_fma_f32 v77, v33, v33, s40
v_fma_f32 v78, v34, v34, s40
v_mfma_f32_16x16x32_bf16 v[20:23], v[48:51], a[24:27], v[20:23]
ds_read_b64_tr_b16 v[36:37], v3 offset:20480
v_fma_f32 v79, v35, v35, s40
v_mul_f32 v72, v28, v72
v_add_u32 v18, 0x10000, v10
ds_read_b128 a[0:3], v18 offset:40960
s_waitcnt lgkmcnt(10)
v_mfma_f32_16x16x32_bf16 v[20:23], v[52:55], a[32:35], v[20:23]
ds_read_b64_tr_b16 v[38:39], v3 offset:20992
v_mul_f32 v73, v29, v73
v_mul_f32 v74, v30, v74
v_add_u32 v19, 0x10000, v10
ds_read_b128 a[4:7], v19 offset:41984
s_waitcnt lgkmcnt(10)
v_mfma_f32_16x16x32_bf16 v[20:23], v[56:59], a[40:43], v[20:23]
ds_read_b64_tr_b16 v[40:41], v2 offset:16384
v_mul_f32 v75, v31, v75
v_mul_f32 v76, v32, v76
v_mfma_f32_16x16x32_bf16 v[24:27], v[48:51], a[28:31], v[24:27]
s_add_u32 m0, s34, 40960
s_add_u32 s35, s72, s80
buffer_load_dwordx4 v9, s[12:15], s35 offen  lds
ds_read_b64_tr_b16 v[42:43], v2 offset:16896
v_mul_f32 v77, v33, v77
v_mul_f32 v78, v34, v78
v_add_u32 v17, 0x10000, v10
ds_read_b128 a[8:11], v17 offset:45056
v_mfma_f32_16x16x32_bf16 v[24:27], v[52:55], a[36:39], v[24:27]
ds_read_b64_tr_b16 v[44:45], v2 offset:20480
v_mul_f32 v79, v35, v79
v_exp_f32 v72, v72
v_add_u32 v18, 0x10000, v10
ds_read_b128 a[12:15], v18 offset:46080
v_mfma_f32_16x16x32_bf16 v[24:27], v[56:59], a[44:47], v[24:27]
ds_read_b64_tr_b16 v[46:47], v2 offset:20992
v_exp_f32 v73, v73
s_waitcnt vmcnt(4) lgkmcnt(1)
s_barrier
v_mfma_f32_16x16x32_bf16 v[20:23], v[60:63], a[48:51], v[20:23]
ds_read_b64_tr_b16 v[48:49], v3 offset:24576
v_exp_f32 v74, v74
v_add_u32 v19, 0x10000, v10
ds_read_b128 a[16:19], v19 offset:49152
v_mfma_f32_16x16x32_bf16 v[20:23], v[64:67], a[56:59], v[20:23]
s_add_u32 m0, s34, 49152
s_add_u32 s35, s73, s80
buffer_load_dwordx4 v9, s[12:15], s35 offen  lds
ds_read_b64_tr_b16 v[50:51], v3 offset:25088
v_exp_f32 v75, v75
v_add_u32 v17, 0x10000, v10
ds_read_b128 a[20:23], v17 offset:50176
v_mfma_f32_16x16x32_bf16 v[20:23], v[68:71], a[64:67], v[20:23]
ds_read_b64_tr_b16 v[52:53], v3 offset:28672
v_exp_f32 v76, v76
v_mfma_f32_16x16x32_bf16 v[24:27], v[60:63], a[52:55], v[24:27]
ds_read_b64_tr_b16 v[54:55], v3 offset:29184
v_exp_f32 v77, v77
v_add_u32 v18, 0x10000, v10
ds_read_b128 a[24:27], v18 offset:53248
v_mfma_f32_16x16x32_bf16 v[24:27], v[64:67], a[60:63], v[24:27]
ds_read_b64_tr_b16 v[56:57], v3 offset:32768
v_exp_f32 v78, v78
v_add_u32 v19, 0x10000, v10
ds_read_b128 a[28:31], v19 offset:54272
v_mfma_f32_16x16x32_bf16 v[24:27], v[68:71], a[68:71], v[24:27]
s_add_u32 m0, s34, 57344
s_add_u32 s35, s74, s80
buffer_load_dwordx4 v9, s[12:15], s35 offen  lds
ds_read_b64_tr_b16 v[58:59], v3 offset:33280
v_exp_f32 v79, v79
v_mfma_f32_16x16x32_bf16 v[20:23], v[36:39], a[72:75], v[20:23]
ds_read_b64_tr_b16 v[60:61], v3 offset:36864
v_add_f32 v72, 1.0, v72
v_add_u32 v17, 0x10000, v10
ds_read_b128 a[32:35], v17 offset:57344
v_mfma_f32_16x16x32_bf16 v[20:23], v[40:43], a[80:83], v[20:23]
ds_read_b64_tr_b16 v[62:63], v3 offset:37376
v_add_f32 v73, 1.0, v73
v_add_f32 v74, 1.0, v74
v_add_f32 v75, 1.0, v75
v_add_u32 v18, 0x10000, v10
ds_read_b128 a[36:39], v18 offset:58368
s_waitcnt lgkmcnt(14)
v_mfma_f32_16x16x32_bf16 v[20:23], v[44:47], a[88:91], v[20:23]
ds_read_b64_tr_b16 v[64:65], v4 offset:0
v_add_f32 v76, 1.0, v76
v_add_f32 v77, 1.0, v77
v_mfma_f32_16x16x32_bf16 v[24:27], v[36:39], a[76:79], v[24:27]
s_add_u32 m0, s34, 65536
s_add_u32 s35, s75, s80
buffer_load_dwordx4 v9, s[12:15], s35 offen  lds
ds_read_b64_tr_b16 v[66:67], v4 offset:512
v_add_f32 v78, 1.0, v78
v_add_f32 v79, 1.0, v79
v_add_u32 v19, 0x10000, v10
ds_read_b128 a[40:43], v19 offset:61440
v_mfma_f32_16x16x32_bf16 v[24:27], v[40:43], a[84:87], v[24:27]
ds_read_b64_tr_b16 v[68:69], v4 offset:4096
v_rcp_f32 v72, v72
v_add_u32 v17, 0x10000, v10
ds_read_b128 a[44:47], v17 offset:62464
v_mfma_f32_16x16x32_bf16 v[24:27], v[44:47], a[92:95], v[24:27]
ds_read_b64_tr_b16 v[70:71], v4 offset:4608
v_rcp_f32 v73, v73
s_waitcnt vmcnt(4) lgkmcnt(1)
s_barrier
v_mfma_f32_16x16x32_bf16 v[20:23], v[48:51], a[96:99], v[20:23]
ds_read_b64_tr_b16 v[36:37], v7 offset:8192
v_rcp_f32 v74, v74
ds_read_b128 a[48:51], v10 offset:0
v_mfma_f32_16x16x32_bf16 v[20:23], v[52:55], a[104:107], v[20:23]
s_add_u32 m0, s34, 16384
s_add_u32 s35, s76, s80
buffer_load_dwordx4 v9, s[12:15], s35 offen  lds
ds_read_b64_tr_b16 v[38:39], v7 offset:10240
v_rcp_f32 v75, v75
ds_read_b128 a[52:55], v10 offset:1024
v_mfma_f32_16x16x32_bf16 v[20:23], v[56:59], a[112:115], v[20:23]
s_add_u32 m0, s34, 73728
s_add_u32 s35, s77, s80
buffer_load_dwordx4 v9, s[12:15], s35 offen  lds
ds_read_b64_tr_b16 v[40:41], v7 offset:12288
v_rcp_f32 v76, v76
v_mfma_f32_16x16x32_bf16 v[24:27], v[48:51], a[100:103], v[24:27]
ds_read_b64_tr_b16 v[42:43], v7 offset:14336
v_rcp_f32 v77, v77
ds_read_b128 a[56:59], v10 offset:4096
v_mfma_f32_16x16x32_bf16 v[24:27], v[52:55], a[108:111], v[24:27]
s_lshl_b32 s80, s25, 7
s_add_u32 s80, s80, 128
s_and_b32 s80, s80, 1023
s_add_u32 m0, s34, 81920
s_add_u32 s35, s69, s80
buffer_load_dwordx4 v9, s[12:15], s35 offen  lds
ds_read_b64_tr_b16 v[44:45], v5 offset:24576
v_rcp_f32 v78, v78
ds_read_b128 a[60:63], v10 offset:5120
v_mfma_f32_16x16x32_bf16 v[24:27], v[56:59], a[116:119], v[24:27]
ds_read_b64_tr_b16 v[46:47], v5 offset:26624
v_rcp_f32 v79, v79
v_mfma_f32_16x16x32_bf16 v[20:23], v[60:63], a[120:123], v[20:23]
ds_read_b64_tr_b16 v[48:49], v5 offset:28672
v_mul_f32 v72, v28, v72
v_mul_f32 v73, v29, v73
ds_read_b128 a[64:67], v10 offset:8192
v_mfma_f32_16x16x32_bf16 v[20:23], v[64:67], a[128:131], v[20:23]
ds_read_b64_tr_b16 v[50:51], v5 offset:30720
v_mul_f32 v74, v30, v74
v_mul_f32 v75, v31, v75
ds_read_b128 a[68:71], v10 offset:9216
s_waitcnt lgkmcnt(14)
v_mfma_f32_16x16x32_bf16 v[20:23], v[68:71], a[136:139], v[20:23]
ds_read_b64_tr_b16 v[52:53], v5 offset:32768
v_mul_f32 v76, v32, v76
v_mul_f32 v77, v33, v77
v_mfma_f32_16x16x32_bf16 v[24:27], v[60:63], a[124:127], v[24:27]
ds_read_b64_tr_b16 v[54:55], v5 offset:34816
v_mul_f32 v78, v34, v78
v_mul_f32 v79, v35, v79
ds_read_b128 a[72:75], v10 offset:12288
v_mfma_f32_16x16x32_bf16 v[24:27], v[64:67], a[132:135], v[24:27]
ds_read_b64_tr_b16 v[56:57], v5 offset:36864
v_cvt_pk_bf16_f32 v88, v72, v73
v_cvt_pk_bf16_f32 v89, v74, v75
ds_read_b128 a[76:79], v10 offset:13312
v_mfma_f32_16x16x32_bf16 v[24:27], v[68:71], a[140:143], v[24:27]
ds_read_b64_tr_b16 v[58:59], v5 offset:38912
v_cvt_pk_bf16_f32 v90, v76, v77
v_cvt_pk_bf16_f32 v91, v78, v79
s_waitcnt vmcnt(4) lgkmcnt(1)
s_barrier
v_mfma_f32_16x16x32_bf16 v[28:31], v[36:39], a[0:3], 0
ds_read_b64_tr_b16 v[60:61], v5 offset:40960
ds_write_b64 v12, v[84:85] offset:0
v_add_u32 v18, 0x20000, v10
ds_read_b128 a[80:83], v18 offset:16384
v_mfma_f32_16x16x32_bf16 v[28:31], v[40:43], a[8:11], v[28:31]
ds_read_b64_tr_b16 v[62:63], v5 offset:43008
ds_write_b64 v12, v[86:87] offset:1024
v_mfma_f32_16x16x32_bf16 v[28:31], v[44:47], a[16:19], v[28:31]
ds_read_b64_tr_b16 v[64:65], v5 offset:45056
ds_write_b64 v12, v[88:89] offset:8192
v_mfma_f32_16x16x32_bf16 v[32:35], v[36:39], a[4:7], 0
ds_read_b64_tr_b16 v[66:67], v5 offset:47104
v_fma_f32 v72, v20, v20, s40
v_fma_f32 v73, v21, v21, s40
v_fma_f32 v74, v22, v22, s40
v_fma_f32 v75, v23, v23, s40
ds_write_b64 v12, v[90:91] offset:9216
v_add_u32 v19, 0x20000, v10
ds_read_b128 a[84:87], v19 offset:17408
v_mfma_f32_16x16x32_bf16 v[32:35], v[40:43], a[12:15], v[32:35]
ds_read_b64_tr_b16 v[68:69], v5 offset:49152
v_fma_f32 v76, v24, v24, s40
v_fma_f32 v77, v25, v25, s40
v_fma_f32 v78, v26, v26, s40
v_fma_f32 v79, v27, v27, s40
v_mfma_f32_16x16x32_bf16 v[32:35], v[44:47], a[20:23], v[32:35]
ds_read_b64_tr_b16 v[70:71], v5 offset:51200
v_mul_f32 v72, v20, v72
v_mul_f32 v73, v21, v73
v_mul_f32 v74, v22, v74
v_mul_f32 v75, v23, v75
v_mfma_f32_16x16x32_bf16 v[28:31], v[48:51], a[24:27], v[28:31]
s_add_u32 m0, s34, 90112
s_add_u32 s35, s70, s80
buffer_load_dwordx4 v9, s[12:15], s35 offen  lds
ds_read_b64_tr_b16 v[36:37], v5 offset:53248
v_mul_f32 v76, v24, v76
v_mul_f32 v77, v25, v77
v_mul_f32 v78, v26, v78
v_mul_f32 v79, v27, v79
v_add_u32 v17, 0x20000, v10
ds_read_b128 a[88:91], v17 offset:20480
v_mfma_f32_16x16x32_bf16 v[28:31], v[52:55], a[32:35], v[28:31]
ds_read_b64_tr_b16 v[38:39], v5 offset:55296
v_exp_f32 v72, v72
v_exp_f32 v73, v73
s_waitcnt lgkmcnt(15)
v_mfma_f32_16x16x32_bf16 v[28:31], v[56:59], a[40:43], v[28:31]
s_add_u32 m0, s34, 98304
s_add_u32 s35, s71, s80
buffer_load_dwordx4 v9, s[12:15], s35 offen  lds
ds_read_b64_tr_b16 v[40:41], v5 offset:57344
v_exp_f32 v74, v74
v_exp_f32 v75, v75
v_mfma_f32_16x16x32_bf16 v[32:35], v[48:51], a[28:31], v[32:35]
ds_read_b64_tr_b16 v[42:43], v5 offset:59392
v_exp_f32 v76, v76
v_exp_f32 v77, v77
v_add_u32 v18, 0x20000, v10
ds_read_b128 a[92:95], v18 offset:21504
v_mfma_f32_16x16x32_bf16 v[32:35], v[52:55], a[36:39], v[32:35]
s_add_u32 m0, s34, 106496
s_add_u32 s35, s72, s80
buffer_load_dwordx4 v9, s[12:15], s35 offen  lds
ds_read_b64_tr_b16 v[44:45], v5 offset:61440
v_exp_f32 v78, v78
v_exp_f32 v79, v79
v_mfma_f32_16x16x32_bf16 v[32:35], v[56:59], a[44:47], v[32:35]
ds_read_b64_tr_b16 v[46:47], v5 offset:63488
v_add_f32 v72, 1.0, v72
v_add_f32 v73, 1.0, v73
s_waitcnt vmcnt(4) lgkmcnt(2)
s_barrier
v_mfma_f32_16x16x32_bf16 v[28:31], v[60:63], a[48:51], v[28:31]
ds_read_b64_tr_b16 v[48:49], v6 offset:0
v_add_f32 v74, 1.0, v74
v_add_f32 v75, 1.0, v75
v_add_f32 v76, 1.0, v76
v_add_f32 v77, 1.0, v77
ds_read_b128 a[96:99], v10 offset:0
v_mfma_f32_16x16x32_bf16 v[28:31], v[64:67], a[56:59], v[28:31]
s_add_u32 m0, s34, 32768
s_add_u32 s35, s73, s80
buffer_load_dwordx4 v9, s[12:15], s35 offen  lds
ds_read_b64_tr_b16 v[50:51], v6 offset:2048
v_add_f32 v78, 1.0, v78
v_add_f32 v79, 1.0, v79
v_rcp_f32 v72, v72
ds_read_b128 a[100:103], v10 offset:1024
v_mfma_f32_16x16x32_bf16 v[28:31], v[68:71], a[64:67], v[28:31]
s_add_u32 m0, s34, 114688
s_add_u32 s35, s74, s80
buffer_load_dwordx4 v9, s[12:15], s35 offen  lds
ds_read_b64_tr_b16 v[52:53], v6 offset:4096
v_rcp_f32 v73, v73
v_rcp_f32 v74, v74
ds_read_b128 a[104:107], v10 offset:4096
v_mfma_f32_16x16x32_bf16 v[32:35], v[60:63], a[52:55], v[32:35]
ds_read_b64_tr_b16 v[54:55], v6 offset:6144
v_rcp_f32 v75, v75
v_rcp_f32 v76, v76
ds_read_b128 a[108:111], v10 offset:5120
v_mfma_f32_16x16x32_bf16 v[32:35], v[64:67], a[60:63], v[32:35]
s_add_u32 m0, s34, 122880
s_add_u32 s35, s75, s80
buffer_load_dwordx4 v9, s[12:15], s35 offen  lds
ds_read_b64_tr_b16 v[56:57], v5 offset:16384
v_rcp_f32 v77, v77
v_rcp_f32 v78, v78
ds_read_b128 a[112:115], v10 offset:8192
v_mfma_f32_16x16x32_bf16 v[32:35], v[68:71], a[68:71], v[32:35]
ds_read_b64_tr_b16 v[58:59], v5 offset:18432
v_rcp_f32 v79, v79
v_mul_f32 v72, v20, v72
ds_read_b128 a[116:119], v10 offset:9216
v_mfma_f32_16x16x32_bf16 v[28:31], v[36:39], a[72:75], v[28:31]
ds_read_b64_tr_b16 v[60:61], v5 offset:20480
v_mul_f32 v73, v21, v73
v_mul_f32 v74, v22, v74
v_mul_f32 v75, v23, v75
v_mul_f32 v76, v24, v76
ds_read_b128 a[120:123], v10 offset:12288
v_mfma_f32_16x16x32_bf16 v[28:31], v[40:43], a[80:83], v[28:31]
ds_read_b64_tr_b16 v[62:63], v5 offset:22528
v_mul_f32 v77, v25, v77
v_mul_f32 v78, v26, v78
v_mul_f32 v79, v27, v79
v_cvt_pk_bf16_f32 v92, v72, v73
ds_read_b128 a[124:127], v10 offset:13312
s_waitcnt lgkmcnt(15)
v_mfma_f32_16x16x32_bf16 v[28:31], v[44:47], a[88:91], v[28:31]
ds_read_b64_tr_b16 v[64:65], v6 offset:8192
v_cvt_pk_bf16_f32 v93, v74, v75
v_cvt_pk_bf16_f32 v94, v76, v77
v_cvt_pk_bf16_f32 v95, v78, v79
v_mfma_f32_16x16x32_bf16 v[32:35], v[36:39], a[76:79], v[32:35]
ds_read_b64_tr_b16 v[66:67], v6 offset:10240
ds_write_b64 v12, v[92:93] offset:24576
v_mfma_f32_16x16x32_bf16 v[32:35], v[40:43], a[84:87], v[32:35]
ds_read_b64_tr_b16 v[68:69], v6 offset:12288
ds_write_b64 v12, v[94:95] offset:25600
v_mfma_f32_16x16x32_bf16 v[32:35], v[44:47], a[92:95], v[32:35]
ds_read_b64_tr_b16 v[70:71], v6 offset:14336
s_waitcnt vmcnt(4) lgkmcnt(1)
s_barrier
v_mfma_f32_16x16x32_bf16 v[28:31], v[48:51], a[96:99], v[28:31]
ds_read_b64_tr_b16 v[36:37], v6 offset:16384
ds_read_b128 a[128:131], v10 offset:24576
ds_read_b128 a[132:135], v10 offset:25600
v_mfma_f32_16x16x32_bf16 v[28:31], v[52:55], a[104:107], v[28:31]
s_add_u32 m0, s34, 0
s_add_u32 s35, s76, s80
buffer_load_dwordx4 v9, s[12:15], s35 offen  lds
ds_read_b64_tr_b16 v[38:39], v6 offset:18432
ds_read_b128 a[136:139], v10 offset:28672
v_mfma_f32_16x16x32_bf16 v[28:31], v[56:59], a[112:115], v[28:31]
ds_read_b64_tr_b16 v[40:41], v6 offset:20480
ds_read_b128 a[140:143], v10 offset:29696
v_mfma_f32_16x16x32_bf16 v[32:35], v[48:51], a[100:103], v[32:35]
s_add_u32 m0, s34, 8192
s_add_u32 s35, s77, s80
buffer_load_dwordx4 v9, s[12:15], s35 offen  lds
ds_read_b64_tr_b16 v[42:43], v6 offset:22528
v_mfma_f32_16x16x32_bf16 v[32:35], v[52:55], a[108:111], v[32:35]
ds_read_b64_tr_b16 v[44:45], v6 offset:24576
v_mbcnt_lo_u32_b32 v17, -1, 0
v_mbcnt_hi_u32_b32 v17, -1, v17
s_mov_b32 s4, s54
s_mov_b32 s5, s55
s_mov_b32 s20, s52
s_mov_b32 s21, s53
v_mfma_f32_16x16x32_bf16 v[32:35], v[56:59], a[116:119], v[32:35]
s_add_u32 s80, s80, 128
s_and_b32 s80, s80, 1023
s_add_u32 m0, s34, 40960
s_add_u32 s35, s69, s80
buffer_load_dwordx4 v9, s[12:15], s35 offen  lds
ds_read_b64_tr_b16 v[46:47], v6 offset:26624
s_mul_i32 s36, s25, 65536
v_subrev_u32 v2, s36, v16
v_and_b32 v18, 7, v17
s_lshl_b32 s36, s38, 8
s_mul_i32 s39, s24, 0
s_add_u32 s36, s36, s39
s_add_u32 s36, s36, 33554432
v_lshl_add_u32 v12, v18, 2, s36
v_mfma_f32_16x16x32_bf16 v[28:31], v[60:63], a[120:123], v[28:31]
ds_read_b64_tr_b16 v[48:49], v6 offset:28672
s_lshl_b32 s36, s38, 5
s_add_u32 s36, s36, 33619968
v_lshl_add_u32 v15, v18, 2, s36
v_sub_u32 v19, s25, v18
v_and_b32 v19, 7, v19
s_waitcnt lgkmcnt(4)
v_mfma_f32_16x16x32_bf16 v[28:31], v[64:67], a[128:131], v[28:31]
ds_read_b64_tr_b16 v[50:51], v6 offset:30720
v_subrev_u32 v19, 1, v19
v_cmp_gt_u32 s[30:31], 6, v19
v_cmp_gt_u32 s[44:45], 4, v19
v_mfma_f32_16x16x32_bf16 v[28:31], v[68:71], a[136:139], v[28:31]
s_add_u32 m0, s34, 49152
s_add_u32 s35, s70, s80
buffer_load_dwordx4 v9, s[12:15], s35 offen  lds
ds_read_b64_tr_b16 v[52:53], v6 offset:32768
v_cmp_eq_u32 s[32:33], -1, v19
s_or_b64 s[44:45], s[44:45], s[32:33]
s_mul_i32 s36, s26, 589824
s_lshl_b32 s39, s25, 10
s_add_u32 s36, s36, s39
s_lshl_b32 s39, s24, 7
s_add_u32 s36, s36, s39
s_add_u32 s36, s36, 65536
v_lshl_add_u32 v3, v18, 4, s36
v_lshrrev_b32 v19, 3, v17
v_mfma_f32_16x16x32_bf16 v[32:35], v[60:63], a[124:127], v[32:35]
ds_read_b64_tr_b16 v[54:55], v6 offset:34816
v_mul_u32_u24 v19, 73728, v19
v_add_u32 v3, v3, v19
s_lshr_b32 s36, s25, 2
s_lshl_b32 s36, s36, 5
s_lshl_b32 s39, s26, 6
s_add_u32 s36, s36, s39
s_and_b32 s39, s24, 1
s_lshl_b32 s39, s39, 3
s_add_u32 s36, s36, s39
v_add_u32 v18, s36, v18
v_mfma_f32_16x16x32_bf16 v[32:35], v[64:67], a[132:135], v[32:35]
s_add_u32 m0, s34, 57344
s_add_u32 s35, s71, s80
buffer_load_dwordx4 v9, s[12:15], s35 offen  lds
ds_read_b64_tr_b16 v[56:57], v6 offset:36864
v_lshrrev_b32 v19, 5, v17
v_lshl_add_u32 v18, v19, 4, v18
v_mul_u32_u24 v4, 1152, v18
v_mfma_f32_16x16x32_bf16 v[32:35], v[68:71], a[140:143], v[32:35]
ds_read_b64_tr_b16 v[58:59], v6 offset:38912
s_and_b32 s36, s25, 3
s_lshl_b32 s36, s36, 5
s_lshr_b32 s39, s24, 1
s_lshl_b32 s39, s39, 3
s_add_u32 s36, s36, s39
s_add_u32 s36, s36, 1024
v_bfe_u32 v19, v17, 4, 1
v_lshl_add_u32 v19, v19, 2, s36
v_add_u32 v4, v4, v19
s_waitcnt vmcnt(6)
s_barrier
v_mfma_f32_16x16x32_bf16 v[20:23], v[36:39], a[0:3], 0
ds_read_b64_tr_b16 v[60:61], v6 offset:40960
v_mov_b32 v11, v19
s_lshr_b32 s36, s24, 2
s_lshl_b32 s36, s36, 5
s_lshl_b32 s39, s26, 6
s_add_u32 s36, s36, s39
v_and_b32 v18, 15, v17
v_add_u32 v18, s36, v18
s_waitcnt lgkmcnt(9)
v_mfma_f32_16x16x32_bf16 v[20:23], v[40:43], a[8:11], v[20:23]
s_add_u32 m0, s34, 16384
s_add_u32 s35, s72, s80
buffer_load_dwordx4 v9, s[12:15], s35 offen  lds
ds_read_b64_tr_b16 v[62:63], v6 offset:43008
v_mul_u32_u24 v8, 1152, v18
s_lshl_b32 s36, s25, 7
s_and_b32 s39, s24, 3
s_lshl_b32 s39, s39, 5
s_add_u32 s36, s36, s39
v_lshrrev_b32 v18, 4, v17
v_lshl_add_u32 v18, v18, 3, s36
s_waitcnt lgkmcnt(8)
v_mfma_f32_16x16x32_bf16 v[20:23], v[44:47], a[16:19], v[20:23]
ds_read_b64_tr_b16 v[64:65], v6 offset:45056
v_add_u32 v8, v8, v18
v_mov_b32 v0, v18
s_mov_b32 s43, 0xc0088e99
v_mfma_f32_16x16x32_bf16 v[24:27], v[36:39], a[4:7], 0
s_add_u32 m0, s34, 24576
s_add_u32 s35, s73, s80
buffer_load_dwordx4 v9, s[12:15], s35 offen  lds
ds_read_b64_tr_b16 v[66:67], v6 offset:47104
v_cvt_pk_bf16_f32 v108, v28, v29
v_cvt_pk_bf16_f32 v109, v30, v31
v_mfma_f32_16x16x32_bf16 v[24:27], v[40:43], a[12:15], v[24:27]
ds_read_b64_tr_b16 v[68:69], v5 offset:32768
v_cvt_pk_bf16_f32 v110, v32, v33
v_cvt_pk_bf16_f32 v111, v34, v35
v_mfma_f32_16x16x32_bf16 v[24:27], v[44:47], a[20:23], v[24:27]
s_add_u32 m0, s34, 65536
s_add_u32 s35, s74, s80
buffer_load_dwordx4 v9, s[12:15], s35 offen  lds
ds_read_b64_tr_b16 v[70:71], v5 offset:34816
buffer_store_dwordx4 v[108:111], v16, s[16:19], s81 offen sc1
s_waitcnt lgkmcnt(10)
v_mfma_f32_16x16x32_bf16 v[20:23], v[48:51], a[24:27], v[20:23]
ds_read_b64_tr_b16 v[36:37], v5 offset:36864
s_waitcnt lgkmcnt(9)
v_mfma_f32_16x16x32_bf16 v[20:23], v[52:55], a[32:35], v[20:23]
ds_read_b64_tr_b16 v[38:39], v5 offset:38912
s_waitcnt lgkmcnt(8)
v_mfma_f32_16x16x32_bf16 v[20:23], v[56:59], a[40:43], v[20:23]
s_add_u32 m0, s34, 73728
s_add_u32 s35, s75, s80
buffer_load_dwordx4 v9, s[12:15], s35 offen  lds
ds_read_b64_tr_b16 v[40:41], v6 offset:49152
v_mfma_f32_16x16x32_bf16 v[24:27], v[48:51], a[28:31], v[24:27]
ds_read_b64_tr_b16 v[42:43], v6 offset:51200
v_mfma_f32_16x16x32_bf16 v[24:27], v[52:55], a[36:39], v[24:27]
s_add_u32 m0, s34, 131072
s_add_u32 s35, s76, s80
buffer_load_dwordx4 v9, s[12:15], s35 offen  lds
ds_read_b64_tr_b16 v[44:45], v6 offset:53248
v_mfma_f32_16x16x32_bf16 v[24:27], v[56:59], a[44:47], v[24:27]
ds_read_b64_tr_b16 v[46:47], v6 offset:55296
s_waitcnt vmcnt(9)
s_barrier
s_waitcnt lgkmcnt(10)
v_mfma_f32_16x16x32_bf16 v[20:23], v[60:63], a[48:51], v[20:23]
ds_read_b64_tr_b16 v[48:49], v6 offset:57344
s_waitcnt lgkmcnt(9)
v_mfma_f32_16x16x32_bf16 v[20:23], v[64:67], a[56:59], v[20:23]
s_add_u32 m0, s34, 81920
s_add_u32 s35, s77, s80
buffer_load_dwordx4 v9, s[12:15], s35 offen  lds
ds_read_b64_tr_b16 v[50:51], v6 offset:59392
s_waitcnt lgkmcnt(8)
v_mfma_f32_16x16x32_bf16 v[20:23], v[68:71], a[64:67], v[20:23]
ds_read_b64_tr_b16 v[52:53], v6 offset:61440
v_mfma_f32_16x16x32_bf16 v[24:27], v[60:63], a[52:55], v[24:27]
s_add_u32 s80, s80, 128
s_and_b32 s80, s80, 1023
s_add_u32 m0, s34, 90112
s_add_u32 s35, s69, s80
buffer_load_dwordx4 v9, s[12:15], s35 offen  lds
ds_read_b64_tr_b16 v[54:55], v6 offset:63488
v_mfma_f32_16x16x32_bf16 v[24:27], v[64:67], a[60:63], v[24:27]
ds_read_b64_tr_b16 v[56:57], v5 offset:0
v_mfma_f32_16x16x32_bf16 v[24:27], v[68:71], a[68:71], v[24:27]
s_add_u32 m0, s34, 98304
s_add_u32 s35, s70, s80
buffer_load_dwordx4 v9, s[12:15], s35 offen  lds
ds_read_b64_tr_b16 v[58:59], v5 offset:2048
s_waitcnt lgkmcnt(10)
v_mfma_f32_16x16x32_bf16 v[20:23], v[36:39], a[72:75], v[20:23]
ds_read_b64_tr_b16 v[60:61], v5 offset:4096
s_waitcnt lgkmcnt(9)
v_mfma_f32_16x16x32_bf16 v[20:23], v[40:43], a[80:83], v[20:23]
ds_read_b64_tr_b16 v[62:63], v5 offset:6144
s_waitcnt lgkmcnt(8)
v_mfma_f32_16x16x32_bf16 v[20:23], v[44:47], a[88:91], v[20:23]
s_add_u32 m0, s34, 139264
s_add_u32 s35, s71, s80
buffer_load_dwordx4 v9, s[12:15], s35 offen  lds
ds_read_b64_tr_b16 v[64:65], v5 offset:8192
v_mfma_f32_16x16x32_bf16 v[24:27], v[36:39], a[76:79], v[24:27]
ds_read_b64_tr_b16 v[66:67], v5 offset:10240
v_mfma_f32_16x16x32_bf16 v[24:27], v[40:43], a[84:87], v[24:27]
s_add_u32 m0, s34, 147456
s_add_u32 s35, s72, s80
buffer_load_dwordx4 v9, s[12:15], s35 offen  lds
ds_read_b64_tr_b16 v[68:69], v5 offset:12288
v_mfma_f32_16x16x32_bf16 v[24:27], v[44:47], a[92:95], v[24:27]
ds_read_b64_tr_b16 v[70:71], v5 offset:14336
s_waitcnt vmcnt(11)
s_barrier
s_waitcnt lgkmcnt(10)
v_mfma_f32_16x16x32_bf16 v[20:23], v[48:51], a[96:99], v[20:23]
ds_read_b64_tr_b16 v[36:37], v5 offset:40960
s_waitcnt lgkmcnt(9)
v_mfma_f32_16x16x32_bf16 v[20:23], v[52:55], a[104:107], v[20:23]
s_add_u32 m0, s34, 32768
s_add_u32 s35, s73, s80
buffer_load_dwordx4 v9, s[12:15], s35 offen  lds
ds_read_b64_tr_b16 v[38:39], v5 offset:43008
s_waitcnt lgkmcnt(8)
v_mfma_f32_16x16x32_bf16 v[20:23], v[56:59], a[112:115], v[20:23]
ds_read_b64_tr_b16 v[40:41], v5 offset:45056
v_mfma_f32_16x16x32_bf16 v[24:27], v[48:51], a[100:103], v[24:27]
ds_read_b64_tr_b16 v[42:43], v5 offset:47104
v_mfma_f32_16x16x32_bf16 v[24:27], v[52:55], a[108:111], v[24:27]
ds_read_b64_tr_b16 v[44:45], v5 offset:49152
v_mfma_f32_16x16x32_bf16 v[24:27], v[56:59], a[116:119], v[24:27]
s_add_u32 m0, s34, 106496
s_add_u32 s35, s74, s80
buffer_load_dwordx4 v9, s[12:15], s35 offen  lds
ds_read_b64_tr_b16 v[46:47], v5 offset:51200
s_waitcnt lgkmcnt(10)
v_mfma_f32_16x16x32_bf16 v[20:23], v[60:63], a[120:123], v[20:23]
ds_read_b64_tr_b16 v[48:49], v5 offset:53248
s_waitcnt lgkmcnt(9)
v_mfma_f32_16x16x32_bf16 v[20:23], v[64:67], a[128:131], v[20:23]
ds_read_b64_tr_b16 v[50:51], v5 offset:55296
s_waitcnt lgkmcnt(8)
v_mfma_f32_16x16x32_bf16 v[20:23], v[68:71], a[136:139], v[20:23]
ds_read_b64_tr_b16 v[52:53], v5 offset:57344
v_mfma_f32_16x16x32_bf16 v[24:27], v[60:63], a[124:127], v[24:27]
s_add_u32 m0, s34, 114688
s_add_u32 s35, s75, s80
buffer_load_dwordx4 v9, s[12:15], s35 offen  lds
ds_read_b64_tr_b16 v[54:55], v5 offset:59392
v_mfma_f32_16x16x32_bf16 v[24:27], v[64:67], a[132:135], v[24:27]
ds_read_b64_tr_b16 v[56:57], v5 offset:61440
v_mfma_f32_16x16x32_bf16 v[24:27], v[68:71], a[140:143], v[24:27]
ds_read_b64_tr_b16 v[58:59], v5 offset:63488
s_waitcnt vmcnt(11)
s_barrier
s_waitcnt lgkmcnt(10)
v_mfma_f32_16x16x32_bf16 v[28:31], v[36:39], a[0:3], 0
ds_read_b64_tr_b16 v[60:61], v5 offset:16384
s_waitcnt lgkmcnt(9)
v_mfma_f32_16x16x32_bf16 v[28:31], v[40:43], a[8:11], v[28:31]
s_add_u32 m0, s34, 0
s_add_u32 s35, s76, s80
buffer_load_dwordx4 v9, s[12:15], s35 offen  lds
ds_read_b64_tr_b16 v[62:63], v5 offset:18432
s_waitcnt lgkmcnt(8)
v_mfma_f32_16x16x32_bf16 v[28:31], v[44:47], a[16:19], v[28:31]
ds_read_b64_tr_b16 v[64:65], v5 offset:20480
v_mfma_f32_16x16x32_bf16 v[32:35], v[36:39], a[4:7], 0
ds_read_b64_tr_b16 v[66:67], v5 offset:22528
v_cvt_pk_bf16_f32 v80, v20, v21
v_cvt_pk_bf16_f32 v81, v22, v23
v_mfma_f32_16x16x32_bf16 v[32:35], v[40:43], a[12:15], v[32:35]
ds_read_b64_tr_b16 v[68:69], v5 offset:24576
v_cvt_pk_bf16_f32 v82, v24, v25
v_cvt_pk_bf16_f32 v83, v26, v27
v_mfma_f32_16x16x32_bf16 v[32:35], v[44:47], a[20:23], v[32:35]
s_add_u32 m0, s34, 8192
s_add_u32 s35, s77, s80
buffer_load_dwordx4 v9, s[12:15], s35 offen  lds
ds_read_b64_tr_b16 v[70:71], v5 offset:26624
s_lshl_b32 s81, s25, 13
s_add_u32 s81, s81, 8192
s_and_b32 s81, s81, 65535
buffer_store_dwordx4 v[80:83], v16, s[16:19], s81 offen sc1
s_waitcnt lgkmcnt(10)
v_mfma_f32_16x16x32_bf16 v[28:31], v[48:51], a[24:27], v[28:31]
ds_read_b64_tr_b16 v[36:37], v5 offset:28672
s_waitcnt lgkmcnt(9)
v_mfma_f32_16x16x32_bf16 v[28:31], v[52:55], a[32:35], v[28:31]
ds_read_b64_tr_b16 v[38:39], v5 offset:30720
s_waitcnt lgkmcnt(8)
v_mfma_f32_16x16x32_bf16 v[28:31], v[56:59], a[40:43], v[28:31]
ds_read_b64_tr_b16 v[40:41], v6 offset:0
v_mfma_f32_16x16x32_bf16 v[32:35], v[48:51], a[28:31], v[32:35]
s_add_u32 s80, s80, 128
s_and_b32 s80, s80, 1023
s_add_u32 m0, s34, 122880
s_add_u32 s35, s69, s80
buffer_load_dwordx4 v9, s[12:15], s35 offen  lds
ds_read_b64_tr_b16 v[42:43], v6 offset:2048
v_mfma_f32_16x16x32_bf16 v[32:35], v[52:55], a[36:39], v[32:35]
ds_read_b64_tr_b16 v[44:45], v6 offset:4096
v_mfma_f32_16x16x32_bf16 v[32:35], v[56:59], a[44:47], v[32:35]
ds_read_b64_tr_b16 v[46:47], v6 offset:6144
s_waitcnt vmcnt(11)
s_barrier
s_mul_i32 s36, s26, 1792
s_sub_u32 s36, 65536, s36
s_mov_b64 exec, 1
buffer_store_dword v13, v14, s[16:19], s36 offen sc1
s_mov_b64 exec, -1
s_waitcnt lgkmcnt(10)
v_mfma_f32_16x16x32_bf16 v[28:31], v[60:63], a[48:51], v[28:31]
ds_read_b64_tr_b16 v[48:49], v6 offset:8192
s_waitcnt lgkmcnt(9)
v_mfma_f32_16x16x32_bf16 v[28:31], v[64:67], a[56:59], v[28:31]
s_add_u32 m0, s34, 40960
s_add_u32 s35, s70, s80
buffer_load_dwordx4 v9, s[12:15], s35 offen  lds
ds_read_b64_tr_b16 v[50:51], v6 offset:10240
s_waitcnt lgkmcnt(8)
v_mfma_f32_16x16x32_bf16 v[28:31], v[68:71], a[64:67], v[28:31]
ds_read_b64_tr_b16 v[52:53], v6 offset:12288
v_mfma_f32_16x16x32_bf16 v[32:35], v[60:63], a[52:55], v[32:35]
ds_read_b64_tr_b16 v[54:55], v6 offset:14336
v_mfma_f32_16x16x32_bf16 v[32:35], v[64:67], a[60:63], v[32:35]
ds_read_b64_tr_b16 v[56:57], v7 offset:0
v_mfma_f32_16x16x32_bf16 v[32:35], v[68:71], a[68:71], v[32:35]
s_add_u32 m0, s34, 49152
s_add_u32 s35, s71, s80
buffer_load_dwordx4 v9, s[12:15], s35 offen  lds
ds_read_b64_tr_b16 v[58:59], v7 offset:2048
s_waitcnt lgkmcnt(10)
v_mfma_f32_16x16x32_bf16 v[28:31], v[36:39], a[72:75], v[28:31]
ds_read_b64_tr_b16 v[60:61], v7 offset:4096
s_waitcnt lgkmcnt(9)
v_mfma_f32_16x16x32_bf16 v[28:31], v[40:43], a[80:83], v[28:31]
ds_read_b64_tr_b16 v[62:63], v7 offset:6144
s_waitcnt lgkmcnt(8)
v_mfma_f32_16x16x32_bf16 v[28:31], v[44:47], a[88:91], v[28:31]
ds_read_b64_tr_b16 v[64:65], v6 offset:16384
v_mfma_f32_16x16x32_bf16 v[32:35], v[36:39], a[76:79], v[32:35]
s_add_u32 m0, s34, 57344
s_add_u32 s35, s72, s80
buffer_load_dwordx4 v9, s[12:15], s35 offen  lds
ds_read_b64_tr_b16 v[66:67], v6 offset:18432
v_mfma_f32_16x16x32_bf16 v[32:35], v[40:43], a[84:87], v[32:35]
ds_read_b64_tr_b16 v[68:69], v6 offset:20480
v_mfma_f32_16x16x32_bf16 v[32:35], v[44:47], a[92:95], v[32:35]
ds_read_b64_tr_b16 v[70:71], v6 offset:22528
s_waitcnt vmcnt(12)
s_barrier
s_waitcnt lgkmcnt(10)
v_mfma_f32_16x16x32_bf16 v[28:31], v[48:51], a[96:99], v[28:31]
ds_read_b64_tr_b16 v[36:37], v6 offset:24576
s_waitcnt lgkmcnt(9)
v_mfma_f32_16x16x32_bf16 v[28:31], v[52:55], a[104:107], v[28:31]
s_add_u32 m0, s34, 16384
s_add_u32 s35, s73, s80
buffer_load_dwordx4 v9, s[12:15], s35 offen  lds
ds_read_b64_tr_b16 v[38:39], v6 offset:26624
s_waitcnt lgkmcnt(8)
v_mfma_f32_16x16x32_bf16 v[28:31], v[56:59], a[112:115], v[28:31]
ds_read_b64_tr_b16 v[40:41], v6 offset:28672
v_mfma_f32_16x16x32_bf16 v[32:35], v[48:51], a[100:103], v[32:35]
ds_read_b64_tr_b16 v[42:43], v6 offset:30720
v_mfma_f32_16x16x32_bf16 v[32:35], v[52:55], a[108:111], v[32:35]
ds_read_b64_tr_b16 v[44:45], v6 offset:32768
v_mfma_f32_16x16x32_bf16 v[32:35], v[56:59], a[116:119], v[32:35]
s_add_u32 m0, s34, 24576
s_add_u32 s35, s74, s80
buffer_load_dwordx4 v9, s[12:15], s35 offen  lds
ds_read_b64_tr_b16 v[46:47], v6 offset:34816
s_waitcnt lgkmcnt(10)
v_mfma_f32_16x16x32_bf16 v[28:31], v[60:63], a[120:123], v[28:31]
ds_read_b64_tr_b16 v[48:49], v6 offset:36864
s_waitcnt lgkmcnt(9)
v_mfma_f32_16x16x32_bf16 v[28:31], v[64:67], a[128:131], v[28:31]
ds_read_b64_tr_b16 v[50:51], v6 offset:38912
s_waitcnt lgkmcnt(8)
v_mfma_f32_16x16x32_bf16 v[28:31], v[68:71], a[136:139], v[28:31]
ds_read_b64_tr_b16 v[52:53], v7 offset:8192
v_mfma_f32_16x16x32_bf16 v[32:35], v[60:63], a[124:127], v[32:35]
s_add_u32 m0, s34, 65536
s_add_u32 s35, s75, s80
buffer_load_dwordx4 v9, s[12:15], s35 offen  lds
ds_read_b64_tr_b16 v[54:55], v7 offset:10240
v_mfma_f32_16x16x32_bf16 v[32:35], v[64:67], a[132:135], v[32:35]
ds_read_b64_tr_b16 v[56:57], v7 offset:12288
v_mfma_f32_16x16x32_bf16 v[32:35], v[68:71], a[140:143], v[32:35]
ds_read_b64_tr_b16 v[58:59], v7 offset:14336
s_waitcnt vmcnt(12)
s_barrier
s_waitcnt lgkmcnt(10)
v_mfma_f32_16x16x32_bf16 v[20:23], v[36:39], a[0:3], 0
ds_read_b64_tr_b16 v[60:61], v7 offset:16384
s_waitcnt lgkmcnt(9)
v_mfma_f32_16x16x32_bf16 v[20:23], v[40:43], a[8:11], v[20:23]
s_add_u32 m0, s34, 73728
s_add_u32 s35, s76, s80
buffer_load_dwordx4 v9, s[12:15], s35 offen  lds
ds_read_b64_tr_b16 v[62:63], v7 offset:18432
s_waitcnt lgkmcnt(8)
v_mfma_f32_16x16x32_bf16 v[20:23], v[44:47], a[16:19], v[20:23]
ds_read_b64_tr_b16 v[64:65], v7 offset:20480
v_mfma_f32_16x16x32_bf16 v[24:27], v[36:39], a[4:7], 0
ds_read_b64_tr_b16 v[66:67], v7 offset:22528
v_cvt_pk_bf16_f32 v108, v28, v29
v_cvt_pk_bf16_f32 v109, v30, v31
v_mfma_f32_16x16x32_bf16 v[24:27], v[40:43], a[12:15], v[24:27]
ds_read_b64_tr_b16 v[68:69], v5 offset:32768
v_cvt_pk_bf16_f32 v110, v32, v33
v_cvt_pk_bf16_f32 v111, v34, v35
v_mfma_f32_16x16x32_bf16 v[24:27], v[44:47], a[20:23], v[24:27]
s_add_u32 m0, s34, 81920
s_add_u32 s35, s77, s80
buffer_load_dwordx4 v9, s[12:15], s35 offen  lds
ds_read_b64_tr_b16 v[70:71], v5 offset:34816
s_add_u32 s81, s81, 8192
s_and_b32 s81, s81, 65535
buffer_store_dwordx4 v[108:111], v16, s[16:19], s81 offen sc1
s_waitcnt lgkmcnt(10)
v_mfma_f32_16x16x32_bf16 v[20:23], v[48:51], a[24:27], v[20:23]
ds_read_b64_tr_b16 v[36:37], v5 offset:36864
s_waitcnt lgkmcnt(9)
v_mfma_f32_16x16x32_bf16 v[20:23], v[52:55], a[32:35], v[20:23]
ds_read_b64_tr_b16 v[38:39], v5 offset:38912
s_waitcnt lgkmcnt(8)
v_mfma_f32_16x16x32_bf16 v[20:23], v[56:59], a[40:43], v[20:23]
ds_read_b64_tr_b16 v[40:41], v6 offset:40960
v_mfma_f32_16x16x32_bf16 v[24:27], v[48:51], a[28:31], v[24:27]
s_add_u32 s80, s80, 128
s_and_b32 s80, s80, 1023
s_add_u32 m0, s34, 131072
s_add_u32 s35, s69, s80
buffer_load_dwordx4 v9, s[12:15], s35 offen  lds
ds_read_b64_tr_b16 v[42:43], v6 offset:43008
v_mfma_f32_16x16x32_bf16 v[24:27], v[52:55], a[36:39], v[24:27]
ds_read_b64_tr_b16 v[44:45], v6 offset:45056
v_mfma_f32_16x16x32_bf16 v[24:27], v[56:59], a[44:47], v[24:27]
ds_read_b64_tr_b16 v[46:47], v6 offset:47104
s_waitcnt vmcnt(12)
s_barrier
s_cmp_lg_u32 s24, 0
s_cbranch_scc1 standalone__mixer_channel_mlp__prompt_kernel_nf1
s_add_u32 s36, s25, 1
s_and_b32 s36, s36, 7
s_lshl_b32 s36, s36, 8
s_mov_b64 exec, 1
buffer_store_dword v13, v14, s[16:19], s36 offen sc1
s_mov_b64 exec, -1
standalone__mixer_channel_mlp__prompt_kernel_nf1:
s_waitcnt lgkmcnt(10)
v_mfma_f32_16x16x32_bf16 v[20:23], v[60:63], a[48:51], v[20:23]
ds_read_b64_tr_b16 v[48:49], v6 offset:49152
s_waitcnt lgkmcnt(9)
v_mfma_f32_16x16x32_bf16 v[20:23], v[64:67], a[56:59], v[20:23]
s_add_u32 m0, s34, 90112
s_add_u32 s35, s70, s80
buffer_load_dwordx4 v9, s[12:15], s35 offen  lds
ds_read_b64_tr_b16 v[50:51], v6 offset:51200
s_waitcnt lgkmcnt(8)
v_mfma_f32_16x16x32_bf16 v[20:23], v[68:71], a[64:67], v[20:23]
ds_read_b64_tr_b16 v[52:53], v6 offset:53248
v_mfma_f32_16x16x32_bf16 v[24:27], v[60:63], a[52:55], v[24:27]
ds_read_b64_tr_b16 v[54:55], v6 offset:55296
v_mfma_f32_16x16x32_bf16 v[24:27], v[64:67], a[60:63], v[24:27]
ds_read_b64_tr_b16 v[56:57], v5 offset:0
v_mfma_f32_16x16x32_bf16 v[24:27], v[68:71], a[68:71], v[24:27]
s_add_u32 m0, s34, 98304
s_add_u32 s35, s71, s80
buffer_load_dwordx4 v9, s[12:15], s35 offen  lds
ds_read_b64_tr_b16 v[58:59], v5 offset:2048
s_waitcnt lgkmcnt(10)
v_mfma_f32_16x16x32_bf16 v[20:23], v[36:39], a[72:75], v[20:23]
ds_read_b64_tr_b16 v[60:61], v5 offset:4096
s_waitcnt lgkmcnt(9)
v_mfma_f32_16x16x32_bf16 v[20:23], v[40:43], a[80:83], v[20:23]
ds_read_b64_tr_b16 v[62:63], v5 offset:6144
s_waitcnt lgkmcnt(8)
v_mfma_f32_16x16x32_bf16 v[20:23], v[44:47], a[88:91], v[20:23]
ds_read_b64_tr_b16 v[64:65], v5 offset:8192
v_mfma_f32_16x16x32_bf16 v[24:27], v[36:39], a[76:79], v[24:27]
s_add_u32 m0, s34, 139264
s_add_u32 s35, s72, s80
buffer_load_dwordx4 v9, s[12:15], s35 offen  lds
ds_read_b64_tr_b16 v[66:67], v5 offset:10240
v_mfma_f32_16x16x32_bf16 v[24:27], v[40:43], a[84:87], v[24:27]
ds_read_b64_tr_b16 v[68:69], v5 offset:12288
v_mfma_f32_16x16x32_bf16 v[24:27], v[44:47], a[92:95], v[24:27]
ds_read_b64_tr_b16 v[70:71], v5 offset:14336
s_waitcnt vmcnt(11)
s_barrier
s_waitcnt lgkmcnt(10)
v_mfma_f32_16x16x32_bf16 v[20:23], v[48:51], a[96:99], v[20:23]
ds_read_b64_tr_b16 v[36:37], v6 offset:57344
s_waitcnt lgkmcnt(9)
v_mfma_f32_16x16x32_bf16 v[20:23], v[52:55], a[104:107], v[20:23]
s_add_u32 m0, s34, 32768
s_add_u32 s35, s73, s80
buffer_load_dwordx4 v9, s[12:15], s35 offen  lds
ds_read_b64_tr_b16 v[38:39], v6 offset:59392
s_waitcnt lgkmcnt(8)
v_mfma_f32_16x16x32_bf16 v[20:23], v[56:59], a[112:115], v[20:23]
ds_read_b64_tr_b16 v[40:41], v6 offset:61440
v_mfma_f32_16x16x32_bf16 v[24:27], v[48:51], a[100:103], v[24:27]
ds_read_b64_tr_b16 v[42:43], v6 offset:63488
v_mfma_f32_16x16x32_bf16 v[24:27], v[52:55], a[108:111], v[24:27]
ds_read_b64_tr_b16 v[44:45], v5 offset:40960
v_mfma_f32_16x16x32_bf16 v[24:27], v[56:59], a[116:119], v[24:27]
s_add_u32 m0, s34, 106496
s_add_u32 s35, s74, s80
buffer_load_dwordx4 v9, s[12:15], s35 offen  lds
ds_read_b64_tr_b16 v[46:47], v5 offset:43008
s_waitcnt lgkmcnt(10)
v_mfma_f32_16x16x32_bf16 v[20:23], v[60:63], a[120:123], v[20:23]
ds_read_b64_tr_b16 v[48:49], v5 offset:45056
s_waitcnt lgkmcnt(9)
v_mfma_f32_16x16x32_bf16 v[20:23], v[64:67], a[128:131], v[20:23]
ds_read_b64_tr_b16 v[50:51], v5 offset:47104
s_waitcnt lgkmcnt(8)
v_mfma_f32_16x16x32_bf16 v[20:23], v[68:71], a[136:139], v[20:23]
ds_read_b64_tr_b16 v[52:53], v5 offset:49152
v_mfma_f32_16x16x32_bf16 v[24:27], v[60:63], a[124:127], v[24:27]
s_add_u32 m0, s34, 147456
s_add_u32 s35, s75, s80
buffer_load_dwordx4 v9, s[12:15], s35 offen  lds
ds_read_b64_tr_b16 v[54:55], v5 offset:51200
v_mfma_f32_16x16x32_bf16 v[24:27], v[64:67], a[132:135], v[24:27]
ds_read_b64_tr_b16 v[56:57], v5 offset:53248
v_mfma_f32_16x16x32_bf16 v[24:27], v[68:71], a[140:143], v[24:27]
ds_read_b64_tr_b16 v[58:59], v5 offset:55296
s_waitcnt vmcnt(11)
s_barrier
s_waitcnt lgkmcnt(10)
v_mfma_f32_16x16x32_bf16 v[28:31], v[36:39], a[0:3], 0
ds_read_b64_tr_b16 v[60:61], v5 offset:57344
s_waitcnt lgkmcnt(9)
v_mfma_f32_16x16x32_bf16 v[28:31], v[40:43], a[8:11], v[28:31]
s_add_u32 m0, s34, 0
s_add_u32 s35, s76, s80
buffer_load_dwordx4 v9, s[12:15], s35 offen  lds
ds_read_b64_tr_b16 v[62:63], v5 offset:59392
s_waitcnt lgkmcnt(8)
v_mfma_f32_16x16x32_bf16 v[28:31], v[44:47], a[16:19], v[28:31]
ds_read_b64_tr_b16 v[64:65], v5 offset:61440
v_mfma_f32_16x16x32_bf16 v[32:35], v[36:39], a[4:7], 0
ds_read_b64_tr_b16 v[66:67], v5 offset:63488
v_cvt_pk_bf16_f32 v80, v20, v21
v_cvt_pk_bf16_f32 v81, v22, v23
v_mfma_f32_16x16x32_bf16 v[32:35], v[40:43], a[12:15], v[32:35]
ds_read_b64_tr_b16 v[68:69], v5 offset:16384
v_cvt_pk_bf16_f32 v82, v24, v25
v_cvt_pk_bf16_f32 v83, v26, v27
v_mfma_f32_16x16x32_bf16 v[32:35], v[44:47], a[20:23], v[32:35]
s_add_u32 m0, s34, 8192
s_add_u32 s35, s77, s80
buffer_load_dwordx4 v9, s[12:15], s35 offen  lds
ds_read_b64_tr_b16 v[70:71], v5 offset:18432
s_add_u32 s81, s81, 8192
s_and_b32 s81, s81, 65535
buffer_store_dwordx4 v[80:83], v16, s[16:19], s81 offen sc1
s_waitcnt lgkmcnt(10)
v_mfma_f32_16x16x32_bf16 v[28:31], v[48:51], a[24:27], v[28:31]
ds_read_b64_tr_b16 v[36:37], v5 offset:20480
s_waitcnt lgkmcnt(9)
v_mfma_f32_16x16x32_bf16 v[28:31], v[52:55], a[32:35], v[28:31]
ds_read_b64_tr_b16 v[38:39], v5 offset:22528
s_waitcnt lgkmcnt(8)
v_mfma_f32_16x16x32_bf16 v[28:31], v[56:59], a[40:43], v[28:31]
ds_read_b64_tr_b16 v[40:41], v5 offset:24576
v_mfma_f32_16x16x32_bf16 v[32:35], v[48:51], a[28:31], v[32:35]
s_add_u32 s80, s80, 128
s_and_b32 s80, s80, 1023
s_add_u32 m0, s34, 114688
s_add_u32 s35, s69, s80
buffer_load_dwordx4 v9, s[12:15], s35 offen  lds
ds_read_b64_tr_b16 v[42:43], v5 offset:26624
v_mfma_f32_16x16x32_bf16 v[32:35], v[52:55], a[36:39], v[32:35]
ds_read_b64_tr_b16 v[44:45], v5 offset:28672
v_mfma_f32_16x16x32_bf16 v[32:35], v[56:59], a[44:47], v[32:35]
ds_read_b64_tr_b16 v[46:47], v5 offset:30720
s_waitcnt vmcnt(11)
s_barrier
s_cmp_lg_u32 s24, 0
s_cbranch_scc1 standalone__mixer_channel_mlp__prompt_kernel_nf2
s_add_u32 s36, s25, 2
s_and_b32 s36, s36, 7
s_lshl_b32 s36, s36, 8
s_mov_b64 exec, 1
buffer_store_dword v13, v14, s[16:19], s36 offen sc1
s_mov_b64 exec, -1
standalone__mixer_channel_mlp__prompt_kernel_nf2:
s_waitcnt lgkmcnt(10)
v_mfma_f32_16x16x32_bf16 v[28:31], v[60:63], a[48:51], v[28:31]
ds_read_b64_tr_b16 v[48:49], v6 offset:0
s_waitcnt lgkmcnt(9)
v_mfma_f32_16x16x32_bf16 v[28:31], v[64:67], a[56:59], v[28:31]
s_add_u32 m0, s34, 40960
s_add_u32 s35, s70, s80
buffer_load_dwordx4 v9, s[12:15], s35 offen  lds
ds_read_b64_tr_b16 v[50:51], v6 offset:2048
s_waitcnt lgkmcnt(8)
v_mfma_f32_16x16x32_bf16 v[28:31], v[68:71], a[64:67], v[28:31]
ds_read_b64_tr_b16 v[52:53], v6 offset:4096
v_mfma_f32_16x16x32_bf16 v[32:35], v[60:63], a[52:55], v[32:35]
ds_read_b64_tr_b16 v[54:55], v6 offset:6144
v_mfma_f32_16x16x32_bf16 v[32:35], v[64:67], a[60:63], v[32:35]
ds_read_b64_tr_b16 v[56:57], v6 offset:8192
v_mfma_f32_16x16x32_bf16 v[32:35], v[68:71], a[68:71], v[32:35]
s_add_u32 m0, s34, 49152
s_add_u32 s35, s71, s80
buffer_load_dwordx4 v9, s[12:15], s35 offen  lds
ds_read_b64_tr_b16 v[58:59], v6 offset:10240
s_waitcnt lgkmcnt(10)
v_mfma_f32_16x16x32_bf16 v[28:31], v[36:39], a[72:75], v[28:31]
ds_read_b64_tr_b16 v[60:61], v6 offset:12288
s_waitcnt lgkmcnt(9)
v_mfma_f32_16x16x32_bf16 v[28:31], v[40:43], a[80:83], v[28:31]
ds_read_b64_tr_b16 v[62:63], v6 offset:14336
s_waitcnt lgkmcnt(8)
v_mfma_f32_16x16x32_bf16 v[28:31], v[44:47], a[88:91], v[28:31]
ds_read_b64_tr_b16 v[64:65], v6 offset:16384
v_mfma_f32_16x16x32_bf16 v[32:35], v[36:39], a[76:79], v[32:35]
s_add_u32 m0, s34, 122880
s_add_u32 s35, s72, s80
buffer_load_dwordx4 v9, s[12:15], s35 offen  lds
ds_read_b64_tr_b16 v[66:67], v6 offset:18432
v_mfma_f32_16x16x32_bf16 v[32:35], v[40:43], a[84:87], v[32:35]
ds_read_b64_tr_b16 v[68:69], v6 offset:20480
v_mfma_f32_16x16x32_bf16 v[32:35], v[44:47], a[92:95], v[32:35]
ds_read_b64_tr_b16 v[70:71], v6 offset:22528
s_waitcnt vmcnt(11)
s_barrier
s_waitcnt lgkmcnt(10)
v_mfma_f32_16x16x32_bf16 v[28:31], v[48:51], a[96:99], v[28:31]
ds_read_b64_tr_b16 v[36:37], v7 offset:0
s_waitcnt lgkmcnt(9)
v_mfma_f32_16x16x32_bf16 v[28:31], v[52:55], a[104:107], v[28:31]
s_add_u32 m0, s34, 16384
s_add_u32 s35, s73, s80
buffer_load_dwordx4 v9, s[12:15], s35 offen  lds
ds_read_b64_tr_b16 v[38:39], v7 offset:2048
s_waitcnt lgkmcnt(8)
v_mfma_f32_16x16x32_bf16 v[28:31], v[56:59], a[112:115], v[28:31]
ds_read_b64_tr_b16 v[40:41], v7 offset:4096
v_mfma_f32_16x16x32_bf16 v[32:35], v[48:51], a[100:103], v[32:35]
ds_read_b64_tr_b16 v[42:43], v7 offset:6144
v_mfma_f32_16x16x32_bf16 v[32:35], v[52:55], a[108:111], v[32:35]
ds_read_b64_tr_b16 v[44:45], v6 offset:24576
v_mfma_f32_16x16x32_bf16 v[32:35], v[56:59], a[116:119], v[32:35]
s_add_u32 m0, s34, 24576
s_add_u32 s35, s74, s80
buffer_load_dwordx4 v9, s[12:15], s35 offen  lds
ds_read_b64_tr_b16 v[46:47], v6 offset:26624
s_waitcnt lgkmcnt(10)
v_mfma_f32_16x16x32_bf16 v[28:31], v[60:63], a[120:123], v[28:31]
ds_read_b64_tr_b16 v[48:49], v6 offset:28672
s_waitcnt lgkmcnt(9)
v_mfma_f32_16x16x32_bf16 v[28:31], v[64:67], a[128:131], v[28:31]
ds_read_b64_tr_b16 v[50:51], v6 offset:30720
s_waitcnt lgkmcnt(8)
v_mfma_f32_16x16x32_bf16 v[28:31], v[68:71], a[136:139], v[28:31]
ds_read_b64_tr_b16 v[52:53], v6 offset:32768
v_mfma_f32_16x16x32_bf16 v[32:35], v[60:63], a[124:127], v[32:35]
s_add_u32 m0, s34, 57344
s_add_u32 s35, s75, s80
buffer_load_dwordx4 v9, s[12:15], s35 offen  lds
ds_read_b64_tr_b16 v[54:55], v6 offset:34816
v_mfma_f32_16x16x32_bf16 v[32:35], v[64:67], a[132:135], v[32:35]
ds_read_b64_tr_b16 v[56:57], v6 offset:36864
v_mfma_f32_16x16x32_bf16 v[32:35], v[68:71], a[140:143], v[32:35]
ds_read_b64_tr_b16 v[58:59], v6 offset:38912
s_waitcnt vmcnt(7)
s_barrier
s_cmp_lg_u32 s24, 0
s_cbranch_scc1 standalone__mixer_channel_mlp__prompt_kernel_nf3
s_add_u32 s36, s25, 3
s_and_b32 s36, s36, 7
s_lshl_b32 s36, s36, 8
s_mov_b64 exec, 1
buffer_store_dword v13, v14, s[16:19], s36 offen sc1
s_mov_b64 exec, -1
standalone__mixer_channel_mlp__prompt_kernel_nf3:
s_waitcnt lgkmcnt(10)
v_mfma_f32_16x16x32_bf16 v[20:23], v[36:39], a[0:3], 0
ds_read_b64_tr_b16 v[60:61], v7 offset:8192
s_waitcnt lgkmcnt(9)
v_mfma_f32_16x16x32_bf16 v[20:23], v[40:43], a[8:11], v[20:23]
s_add_u32 m0, s34, 65536
s_add_u32 s35, s76, s80
buffer_load_dwordx4 v9, s[12:15], s35 offen  lds
ds_read_b64_tr_b16 v[62:63], v7 offset:10240
s_waitcnt lgkmcnt(8)
v_mfma_f32_16x16x32_bf16 v[20:23], v[44:47], a[16:19], v[20:23]
ds_read_b64_tr_b16 v[64:65], v7 offset:12288
v_mfma_f32_16x16x32_bf16 v[24:27], v[36:39], a[4:7], 0
ds_read_b64_tr_b16 v[66:67], v7 offset:14336
v_cvt_pk_bf16_f32 v108, v28, v29
v_cvt_pk_bf16_f32 v109, v30, v31
v_mfma_f32_16x16x32_bf16 v[24:27], v[40:43], a[12:15], v[24:27]
ds_read_b64_tr_b16 v[68:69], v5 offset:32768
v_cvt_pk_bf16_f32 v110, v32, v33
v_cvt_pk_bf16_f32 v111, v34, v35
v_mfma_f32_16x16x32_bf16 v[24:27], v[44:47], a[20:23], v[24:27]
s_add_u32 m0, s34, 73728
s_add_u32 s35, s77, s80
buffer_load_dwordx4 v9, s[12:15], s35 offen  lds
ds_read_b64_tr_b16 v[70:71], v5 offset:34816
s_add_u32 s81, s81, 8192
s_and_b32 s81, s81, 65535
buffer_store_dwordx4 v[108:111], v16, s[16:19], s81 offen sc1
s_waitcnt lgkmcnt(10)
v_mfma_f32_16x16x32_bf16 v[20:23], v[48:51], a[24:27], v[20:23]
ds_read_b64_tr_b16 v[36:37], v5 offset:36864
s_waitcnt lgkmcnt(9)
v_mfma_f32_16x16x32_bf16 v[20:23], v[52:55], a[32:35], v[20:23]
ds_read_b64_tr_b16 v[38:39], v5 offset:38912
s_waitcnt lgkmcnt(8)
v_mfma_f32_16x16x32_bf16 v[20:23], v[56:59], a[40:43], v[20:23]
ds_read_b64_tr_b16 v[40:41], v6 offset:40960
v_mfma_f32_16x16x32_bf16 v[24:27], v[48:51], a[28:31], v[24:27]
s_add_u32 s80, s80, 128
s_and_b32 s80, s80, 1023
s_add_u32 m0, s34, 81920
s_add_u32 s35, s69, s80
buffer_load_dwordx4 v9, s[12:15], s35 offen  lds
ds_read_b64_tr_b16 v[42:43], v6 offset:43008
v_mfma_f32_16x16x32_bf16 v[24:27], v[52:55], a[36:39], v[24:27]
ds_read_b64_tr_b16 v[44:45], v6 offset:45056
v_mfma_f32_16x16x32_bf16 v[24:27], v[56:59], a[44:47], v[24:27]
ds_read_b64_tr_b16 v[46:47], v6 offset:47104
s_barrier
s_waitcnt lgkmcnt(10)
v_mfma_f32_16x16x32_bf16 v[20:23], v[60:63], a[48:51], v[20:23]
ds_read_b64_tr_b16 v[48:49], v7 offset:16384
s_waitcnt lgkmcnt(9)
v_mfma_f32_16x16x32_bf16 v[20:23], v[64:67], a[56:59], v[20:23]
s_add_u32 m0, s34, 90112
s_add_u32 s35, s70, s80
buffer_load_dwordx4 v9, s[12:15], s35 offen  lds
ds_read_b64_tr_b16 v[50:51], v7 offset:18432
s_waitcnt lgkmcnt(8)
v_mfma_f32_16x16x32_bf16 v[20:23], v[68:71], a[64:67], v[20:23]
ds_read_b64_tr_b16 v[52:53], v7 offset:20480
v_mfma_f32_16x16x32_bf16 v[24:27], v[60:63], a[52:55], v[24:27]
ds_read_b64_tr_b16 v[54:55], v7 offset:22528
v_mfma_f32_16x16x32_bf16 v[24:27], v[64:67], a[60:63], v[24:27]
ds_read_b64_tr_b16 v[56:57], v5 offset:0
v_mfma_f32_16x16x32_bf16 v[24:27], v[68:71], a[68:71], v[24:27]
s_add_u32 m0, s34, 98304
s_add_u32 s35, s71, s80
buffer_load_dwordx4 v9, s[12:15], s35 offen  lds
ds_read_b64_tr_b16 v[58:59], v5 offset:2048
s_waitcnt lgkmcnt(10)
v_mfma_f32_16x16x32_bf16 v[20:23], v[36:39], a[72:75], v[20:23]
ds_read_b64_tr_b16 v[60:61], v5 offset:4096
s_waitcnt lgkmcnt(9)
v_mfma_f32_16x16x32_bf16 v[20:23], v[40:43], a[80:83], v[20:23]
ds_read_b64_tr_b16 v[62:63], v5 offset:6144
s_waitcnt lgkmcnt(8)
v_mfma_f32_16x16x32_bf16 v[20:23], v[44:47], a[88:91], v[20:23]
ds_read_b64_tr_b16 v[64:65], v5 offset:8192
v_mfma_f32_16x16x32_bf16 v[24:27], v[36:39], a[76:79], v[24:27]
s_add_u32 m0, s34, 131072
s_add_u32 s35, s72, s80
buffer_load_dwordx4 v9, s[12:15], s35 offen  lds
ds_read_b64_tr_b16 v[66:67], v5 offset:10240
v_mfma_f32_16x16x32_bf16 v[24:27], v[40:43], a[84:87], v[24:27]
ds_read_b64_tr_b16 v[68:69], v5 offset:12288
v_mfma_f32_16x16x32_bf16 v[24:27], v[44:47], a[92:95], v[24:27]
ds_read_b64_tr_b16 v[70:71], v5 offset:14336
s_waitcnt vmcnt(4)
s_barrier
s_cmp_lg_u32 s24, 0
s_cbranch_scc1 standalone__mixer_channel_mlp__prompt_kernel_nf4
s_add_u32 s36, s25, 4
s_and_b32 s36, s36, 7
s_lshl_b32 s36, s36, 8
s_mov_b64 exec, 1
buffer_store_dword v13, v14, s[16:19], s36 offen sc1
s_mov_b64 exec, -1
standalone__mixer_channel_mlp__prompt_kernel_nf4:
s_waitcnt lgkmcnt(10)
v_mfma_f32_16x16x32_bf16 v[20:23], v[48:51], a[96:99], v[20:23]
ds_read_b64_tr_b16 v[36:37], v6 offset:49152
s_waitcnt lgkmcnt(9)
v_mfma_f32_16x16x32_bf16 v[20:23], v[52:55], a[104:107], v[20:23]
s_add_u32 m0, s34, 32768
s_add_u32 s35, s73, s80
buffer_load_dwordx4 v9, s[12:15], s35 offen  lds
ds_read_b64_tr_b16 v[38:39], v6 offset:51200
s_waitcnt lgkmcnt(8)
v_mfma_f32_16x16x32_bf16 v[20:23], v[56:59], a[112:115], v[20:23]
ds_read_b64_tr_b16 v[40:41], v6 offset:53248
v_mfma_f32_16x16x32_bf16 v[24:27], v[48:51], a[100:103], v[24:27]
ds_read_b64_tr_b16 v[42:43], v6 offset:55296
v_mfma_f32_16x16x32_bf16 v[24:27], v[52:55], a[108:111], v[24:27]
ds_read_b64_tr_b16 v[44:45], v5 offset:40960
v_mfma_f32_16x16x32_bf16 v[24:27], v[56:59], a[116:119], v[24:27]
s_add_u32 m0, s34, 106496
s_add_u32 s35, s74, s80
buffer_load_dwordx4 v9, s[12:15], s35 offen  lds
ds_read_b64_tr_b16 v[46:47], v5 offset:43008
s_waitcnt lgkmcnt(10)
v_mfma_f32_16x16x32_bf16 v[20:23], v[60:63], a[120:123], v[20:23]
ds_read_b64_tr_b16 v[48:49], v5 offset:45056
s_waitcnt lgkmcnt(9)
v_mfma_f32_16x16x32_bf16 v[20:23], v[64:67], a[128:131], v[20:23]
ds_read_b64_tr_b16 v[50:51], v5 offset:47104
s_waitcnt lgkmcnt(8)
v_mfma_f32_16x16x32_bf16 v[20:23], v[68:71], a[136:139], v[20:23]
ds_read_b64_tr_b16 v[52:53], v5 offset:49152
v_mfma_f32_16x16x32_bf16 v[24:27], v[60:63], a[124:127], v[24:27]
s_add_u32 m0, s34, 139264
s_add_u32 s35, s75, s80
buffer_load_dwordx4 v9, s[12:15], s35 offen  lds
ds_read_b64_tr_b16 v[54:55], v5 offset:51200
v_mfma_f32_16x16x32_bf16 v[24:27], v[64:67], a[132:135], v[24:27]
ds_read_b64_tr_b16 v[56:57], v5 offset:53248
v_mfma_f32_16x16x32_bf16 v[24:27], v[68:71], a[140:143], v[24:27]
ds_read_b64_tr_b16 v[58:59], v5 offset:55296
s_barrier
s_waitcnt lgkmcnt(10)
v_mfma_f32_16x16x32_bf16 v[28:31], v[36:39], a[0:3], 0
ds_read_b64_tr_b16 v[60:61], v6 offset:57344
s_waitcnt lgkmcnt(9)
v_mfma_f32_16x16x32_bf16 v[28:31], v[40:43], a[8:11], v[28:31]
s_add_u32 m0, s34, 0
s_add_u32 s35, s76, s80
buffer_load_dwordx4 v9, s[12:15], s35 offen  lds
ds_read_b64_tr_b16 v[62:63], v6 offset:59392
s_waitcnt lgkmcnt(8)
v_mfma_f32_16x16x32_bf16 v[28:31], v[44:47], a[16:19], v[28:31]
ds_read_b64_tr_b16 v[64:65], v6 offset:61440
v_mfma_f32_16x16x32_bf16 v[32:35], v[36:39], a[4:7], 0
ds_read_b64_tr_b16 v[66:67], v6 offset:63488
v_cvt_pk_bf16_f32 v80, v20, v21
v_cvt_pk_bf16_f32 v81, v22, v23
v_mfma_f32_16x16x32_bf16 v[32:35], v[40:43], a[12:15], v[32:35]
ds_read_b64_tr_b16 v[68:69], v5 offset:16384
v_cvt_pk_bf16_f32 v82, v24, v25
v_cvt_pk_bf16_f32 v83, v26, v27
v_mfma_f32_16x16x32_bf16 v[32:35], v[44:47], a[20:23], v[32:35]
s_add_u32 m0, s34, 8192
s_add_u32 s35, s77, s80
buffer_load_dwordx4 v9, s[12:15], s35 offen  lds
ds_read_b64_tr_b16 v[70:71], v5 offset:18432
s_add_u32 s81, s81, 8192
s_and_b32 s81, s81, 65535
buffer_store_dwordx4 v[80:83], v16, s[16:19], s81 offen sc1
s_waitcnt lgkmcnt(10)
v_mfma_f32_16x16x32_bf16 v[28:31], v[48:51], a[24:27], v[28:31]
ds_read_b64_tr_b16 v[36:37], v5 offset:20480
s_waitcnt lgkmcnt(9)
v_mfma_f32_16x16x32_bf16 v[28:31], v[52:55], a[32:35], v[28:31]
ds_read_b64_tr_b16 v[38:39], v5 offset:22528
s_waitcnt lgkmcnt(8)
v_mfma_f32_16x16x32_bf16 v[28:31], v[56:59], a[40:43], v[28:31]
ds_read_b64_tr_b16 v[40:41], v5 offset:24576
v_mfma_f32_16x16x32_bf16 v[32:35], v[48:51], a[28:31], v[32:35]
s_add_u32 s80, s80, 128
s_and_b32 s80, s80, 1023
s_add_u32 m0, s34, 147456
s_add_u32 s35, s69, s80
buffer_load_dwordx4 v9, s[12:15], s35 offen  lds
ds_read_b64_tr_b16 v[42:43], v5 offset:26624
v_mfma_f32_16x16x32_bf16 v[32:35], v[52:55], a[36:39], v[32:35]
ds_read_b64_tr_b16 v[44:45], v5 offset:28672
v_mfma_f32_16x16x32_bf16 v[32:35], v[56:59], a[44:47], v[32:35]
ds_read_b64_tr_b16 v[46:47], v5 offset:30720
s_barrier
s_waitcnt lgkmcnt(10)
v_mfma_f32_16x16x32_bf16 v[28:31], v[60:63], a[48:51], v[28:31]
ds_read_b64_tr_b16 v[48:49], v5 offset:57344
s_waitcnt lgkmcnt(9)
v_mfma_f32_16x16x32_bf16 v[28:31], v[64:67], a[56:59], v[28:31]
s_add_u32 m0, s34, 40960
s_add_u32 s35, s70, s80
buffer_load_dwordx4 v9, s[12:15], s35 offen  lds
ds_read_b64_tr_b16 v[50:51], v5 offset:59392
s_waitcnt lgkmcnt(8)
v_mfma_f32_16x16x32_bf16 v[28:31], v[68:71], a[64:67], v[28:31]
ds_read_b64_tr_b16 v[52:53], v5 offset:61440
v_mfma_f32_16x16x32_bf16 v[32:35], v[60:63], a[52:55], v[32:35]
ds_read_b64_tr_b16 v[54:55], v5 offset:63488
v_mfma_f32_16x16x32_bf16 v[32:35], v[64:67], a[60:63], v[32:35]
ds_read_b64_tr_b16 v[56:57], v6 offset:0
v_mfma_f32_16x16x32_bf16 v[32:35], v[68:71], a[68:71], v[32:35]
s_add_u32 m0, s34, 49152
s_add_u32 s35, s71, s80
buffer_load_dwordx4 v9, s[12:15], s35 offen  lds
ds_read_b64_tr_b16 v[58:59], v6 offset:2048
s_waitcnt lgkmcnt(10)
v_mfma_f32_16x16x32_bf16 v[28:31], v[36:39], a[72:75], v[28:31]
ds_read_b64_tr_b16 v[60:61], v6 offset:4096
s_waitcnt lgkmcnt(9)
v_mfma_f32_16x16x32_bf16 v[28:31], v[40:43], a[80:83], v[28:31]
ds_read_b64_tr_b16 v[62:63], v6 offset:6144
s_waitcnt lgkmcnt(8)
v_mfma_f32_16x16x32_bf16 v[28:31], v[44:47], a[88:91], v[28:31]
ds_read_b64_tr_b16 v[64:65], v6 offset:8192
buffer_load_dword v10, v12, s[16:19], 0 offen sc1
buffer_load_dword v19, v15, s[16:19], 0 offen sc1
buffer_load_dword v11, v11, s[20:23], 0 offen
buffer_load_dwordx2 v[0:1], v0, s[20:23], 0 offen
v_mfma_f32_16x16x32_bf16 v[32:35], v[36:39], a[76:79], v[32:35]
s_add_u32 m0, s34, 114688
s_add_u32 s35, s72, s80
buffer_load_dwordx4 v9, s[12:15], s35 offen  lds
ds_read_b64_tr_b16 v[66:67], v6 offset:10240
v_mfma_f32_16x16x32_bf16 v[32:35], v[40:43], a[84:87], v[32:35]
ds_read_b64_tr_b16 v[68:69], v6 offset:12288
v_mfma_f32_16x16x32_bf16 v[32:35], v[44:47], a[92:95], v[32:35]
ds_read_b64_tr_b16 v[70:71], v6 offset:14336
s_waitcnt vmcnt(15)
s_barrier
s_waitcnt lgkmcnt(10)
v_mfma_f32_16x16x32_bf16 v[28:31], v[48:51], a[96:99], v[28:31]
ds_read_b64_tr_b16 v[36:37], v6 offset:16384
s_waitcnt lgkmcnt(9)
v_mfma_f32_16x16x32_bf16 v[28:31], v[52:55], a[104:107], v[28:31]
s_add_u32 m0, s34, 16384
s_add_u32 s35, s73, s80
buffer_load_dwordx4 v9, s[12:15], s35 offen  lds
ds_read_b64_tr_b16 v[38:39], v6 offset:18432
s_waitcnt lgkmcnt(8)
v_mfma_f32_16x16x32_bf16 v[28:31], v[56:59], a[112:115], v[28:31]
ds_read_b64_tr_b16 v[40:41], v6 offset:20480
v_mfma_f32_16x16x32_bf16 v[32:35], v[48:51], a[100:103], v[32:35]
ds_read_b64_tr_b16 v[42:43], v6 offset:22528
v_mfma_f32_16x16x32_bf16 v[32:35], v[52:55], a[108:111], v[32:35]
ds_read_b64_tr_b16 v[44:45], v6 offset:24576
v_mfma_f32_16x16x32_bf16 v[32:35], v[56:59], a[116:119], v[32:35]
s_add_u32 m0, s34, 24576
s_add_u32 s35, s74, s80
buffer_load_dwordx4 v9, s[12:15], s35 offen  lds
ds_read_b64_tr_b16 v[46:47], v6 offset:26624
s_waitcnt lgkmcnt(10)
v_mfma_f32_16x16x32_bf16 v[28:31], v[60:63], a[120:123], v[28:31]
ds_read_b64_tr_b16 v[48:49], v6 offset:28672
s_waitcnt lgkmcnt(9)
v_mfma_f32_16x16x32_bf16 v[28:31], v[64:67], a[128:131], v[28:31]
ds_read_b64_tr_b16 v[50:51], v6 offset:30720
s_waitcnt lgkmcnt(8)
v_mfma_f32_16x16x32_bf16 v[28:31], v[68:71], a[136:139], v[28:31]
ds_read_b64_tr_b16 v[52:53], v6 offset:32768
v_mfma_f32_16x16x32_bf16 v[32:35], v[60:63], a[124:127], v[32:35]
s_add_u32 m0, s34, 122880
s_add_u32 s35, s75, s80
buffer_load_dwordx4 v9, s[12:15], s35 offen  lds
ds_read_b64_tr_b16 v[54:55], v6 offset:34816
v_mfma_f32_16x16x32_bf16 v[32:35], v[64:67], a[132:135], v[32:35]
ds_read_b64_tr_b16 v[56:57], v6 offset:36864
v_mfma_f32_16x16x32_bf16 v[32:35], v[68:71], a[140:143], v[32:35]
ds_read_b64_tr_b16 v[58:59], v6 offset:38912
s_waitcnt vmcnt(11)
s_barrier
s_cmp_lg_u32 s24, 0
s_cbranch_scc1 standalone__mixer_channel_mlp__prompt_kernel_nf5
s_add_u32 s36, s25, 5
s_and_b32 s36, s36, 7
s_lshl_b32 s36, s36, 8
s_mov_b64 exec, 1
buffer_store_dword v13, v14, s[16:19], s36 offen sc1
s_mov_b64 exec, -1
standalone__mixer_channel_mlp__prompt_kernel_nf5:
s_waitcnt lgkmcnt(10)
v_mfma_f32_16x16x32_bf16 v[20:23], v[36:39], a[0:3], 0
ds_read_b64_tr_b16 v[60:61], v7 offset:0
s_waitcnt lgkmcnt(9)
v_mfma_f32_16x16x32_bf16 v[20:23], v[40:43], a[8:11], v[20:23]
s_add_u32 m0, s34, 57344
s_add_u32 s35, s76, s80
buffer_load_dwordx4 v9, s[12:15], s35 offen  lds
ds_read_b64_tr_b16 v[62:63], v7 offset:2048
s_waitcnt lgkmcnt(8)
v_mfma_f32_16x16x32_bf16 v[20:23], v[44:47], a[16:19], v[20:23]
ds_read_b64_tr_b16 v[64:65], v7 offset:4096
v_mfma_f32_16x16x32_bf16 v[24:27], v[36:39], a[4:7], 0
ds_read_b64_tr_b16 v[66:67], v7 offset:6144
v_cvt_pk_bf16_f32 v108, v28, v29
v_cvt_pk_bf16_f32 v109, v30, v31
v_mfma_f32_16x16x32_bf16 v[24:27], v[40:43], a[12:15], v[24:27]
ds_read_b64_tr_b16 v[68:69], v5 offset:32768
v_cvt_pk_bf16_f32 v110, v32, v33
v_cvt_pk_bf16_f32 v111, v34, v35
v_mfma_f32_16x16x32_bf16 v[24:27], v[44:47], a[20:23], v[24:27]
ds_read_b64_tr_b16 v[70:71], v5 offset:34816
s_add_u32 s81, s81, 8192
s_and_b32 s81, s81, 65535
buffer_store_dwordx4 v[108:111], v16, s[16:19], s81 offen sc1
s_waitcnt lgkmcnt(10)
v_mfma_f32_16x16x32_bf16 v[20:23], v[48:51], a[24:27], v[20:23]
ds_read_b64_tr_b16 v[36:37], v5 offset:36864
s_waitcnt lgkmcnt(9)
v_mfma_f32_16x16x32_bf16 v[20:23], v[52:55], a[32:35], v[20:23]
s_add_u32 m0, s34, 65536
s_add_u32 s35, s77, s80
buffer_load_dwordx4 v9, s[12:15], s35 offen  lds
ds_read_b64_tr_b16 v[38:39], v5 offset:38912
s_waitcnt lgkmcnt(8)
v_mfma_f32_16x16x32_bf16 v[20:23], v[56:59], a[40:43], v[20:23]
ds_read_b64_tr_b16 v[40:41], v6 offset:40960
v_mfma_f32_16x16x32_bf16 v[24:27], v[48:51], a[28:31], v[24:27]
ds_read_b64_tr_b16 v[42:43], v6 offset:43008
v_mfma_f32_16x16x32_bf16 v[24:27], v[52:55], a[36:39], v[24:27]
ds_read_b64_tr_b16 v[44:45], v6 offset:45056
v_mfma_f32_16x16x32_bf16 v[24:27], v[56:59], a[44:47], v[24:27]
ds_read_b64_tr_b16 v[46:47], v6 offset:47104
s_barrier
s_waitcnt vmcnt(9)
s_mov_b32 s39, 0x10000
standalone__mixer_channel_mlp__prompt_kernel_p8:
v_cmp_ne_u32 vcc, v13, v19
s_and_b64 s[32:33], vcc, exec
s_cbranch_scc0 standalone__mixer_channel_mlp__prompt_kernel_p8_ok
s_sub_u32 s39, s39, 1
s_cbranch_scc1 standalone__mixer_channel_mlp__prompt_kernel_p8_ok
buffer_load_dword v19, v15, s[16:19], 0 offen sc1
s_waitcnt vmcnt(0)
s_branch standalone__mixer_channel_mlp__prompt_kernel_p8
standalone__mixer_channel_mlp__prompt_kernel_p8_ok:
s_mov_b32 vcc_lo, s27
s_mov_b32 vcc_hi, 0
buffer_load_dwordx4 v[104:107], v3, s[16:19], 0 offen sc1
s_mov_b32 s39, 0x10000
standalone__mixer_channel_mlp__prompt_kernel_pe0:
v_cmp_ne_u32 vcc, v13, v10
s_and_b64 s[32:33], vcc, s[44:45]
s_cbranch_scc0 standalone__mixer_channel_mlp__prompt_kernel_pe0_ok
s_sub_u32 s39, s39, 1
s_cbranch_scc1 standalone__mixer_channel_mlp__prompt_kernel_pe0_ok
buffer_load_dword v10, v12, s[16:19], 0 offen sc1
s_waitcnt vmcnt(0)
s_branch standalone__mixer_channel_mlp__prompt_kernel_pe0
standalone__mixer_channel_mlp__prompt_kernel_pe0_ok:
s_mov_b32 vcc_lo, s27
s_mov_b32 vcc_hi, 0
s_sub_u32 s36, s25, 1
s_and_b32 s36, s36, 7
s_mul_i32 s36, s36, 73728
buffer_load_dwordx4 v[84:87], v2, s[16:19], s36 offen sc1
s_sub_u32 s36, s25, 2
s_and_b32 s36, s36, 7
s_mul_i32 s36, s36, 73728
buffer_load_dwordx4 v[88:91], v2, s[16:19], s36 offen sc1
s_sub_u32 s36, s25, 3
s_and_b32 s36, s36, 7
s_mul_i32 s36, s36, 73728
buffer_load_dwordx4 v[92:95], v2, s[16:19], s36 offen sc1
s_sub_u32 s36, s25, 4
s_and_b32 s36, s36, 7
s_mul_i32 s36, s36, 73728
buffer_load_dwordx4 v[96:99], v2, s[16:19], s36 offen sc1
s_waitcnt lgkmcnt(10)
v_mfma_f32_16x16x32_bf16 v[20:23], v[60:63], a[48:51], v[20:23]
ds_read_b64_tr_b16 v[48:49], v7 offset:8192
s_waitcnt lgkmcnt(9)
v_mfma_f32_16x16x32_bf16 v[20:23], v[64:67], a[56:59], v[20:23]
ds_read_b64_tr_b16 v[50:51], v7 offset:10240
s_waitcnt lgkmcnt(8)
v_mfma_f32_16x16x32_bf16 v[20:23], v[68:71], a[64:67], v[20:23]
ds_read_b64_tr_b16 v[52:53], v7 offset:12288
v_mfma_f32_16x16x32_bf16 v[24:27], v[60:63], a[52:55], v[24:27]
ds_read_b64_tr_b16 v[54:55], v7 offset:14336
v_mfma_f32_16x16x32_bf16 v[24:27], v[64:67], a[60:63], v[24:27]
ds_read_b64_tr_b16 v[56:57], v5 offset:0
v_mfma_f32_16x16x32_bf16 v[24:27], v[68:71], a[68:71], v[24:27]
ds_read_b64_tr_b16 v[58:59], v5 offset:2048
s_waitcnt lgkmcnt(10)
v_mfma_f32_16x16x32_bf16 v[20:23], v[36:39], a[72:75], v[20:23]
ds_read_b64_tr_b16 v[60:61], v5 offset:4096
s_waitcnt lgkmcnt(9)
v_mfma_f32_16x16x32_bf16 v[20:23], v[40:43], a[80:83], v[20:23]
ds_read_b64_tr_b16 v[62:63], v5 offset:6144
s_waitcnt lgkmcnt(8)
v_mfma_f32_16x16x32_bf16 v[20:23], v[44:47], a[88:91], v[20:23]
ds_read_b64_tr_b16 v[64:65], v5 offset:8192
v_mfma_f32_16x16x32_bf16 v[24:27], v[36:39], a[76:79], v[24:27]
ds_read_b64_tr_b16 v[66:67], v5 offset:10240
v_mfma_f32_16x16x32_bf16 v[24:27], v[40:43], a[84:87], v[24:27]
ds_read_b64_tr_b16 v[68:69], v5 offset:12288
v_mfma_f32_16x16x32_bf16 v[24:27], v[44:47], a[92:95], v[24:27]
ds_read_b64_tr_b16 v[70:71], v5 offset:14336
s_waitcnt vmcnt(6)
s_barrier
s_cmp_lg_u32 s24, 0
s_cbranch_scc1 standalone__mixer_channel_mlp__prompt_kernel_nf6
s_add_u32 s36, s25, 6
s_and_b32 s36, s36, 7
s_lshl_b32 s36, s36, 8
s_mov_b64 exec, 1
buffer_store_dword v13, v14, s[16:19], s36 offen sc1
s_mov_b64 exec, -1
standalone__mixer_channel_mlp__prompt_kernel_nf6:
s_waitcnt lgkmcnt(10)
v_mfma_f32_16x16x32_bf16 v[20:23], v[48:51], a[96:99], v[20:23]
ds_read_b64_tr_b16 v[36:37], v7 offset:16384
s_waitcnt lgkmcnt(9)
v_mfma_f32_16x16x32_bf16 v[20:23], v[52:55], a[104:107], v[20:23]
ds_read_b64_tr_b16 v[38:39], v7 offset:18432
s_waitcnt lgkmcnt(8)
v_mfma_f32_16x16x32_bf16 v[20:23], v[56:59], a[112:115], v[20:23]
ds_read_b64_tr_b16 v[40:41], v7 offset:20480
v_mfma_f32_16x16x32_bf16 v[24:27], v[48:51], a[100:103], v[24:27]
ds_read_b64_tr_b16 v[42:43], v7 offset:22528
v_mfma_f32_16x16x32_bf16 v[24:27], v[52:55], a[108:111], v[24:27]
ds_read_b64_tr_b16 v[44:45], v5 offset:40960
v_mfma_f32_16x16x32_bf16 v[24:27], v[56:59], a[116:119], v[24:27]
ds_read_b64_tr_b16 v[46:47], v5 offset:43008
s_waitcnt lgkmcnt(10)
v_mfma_f32_16x16x32_bf16 v[20:23], v[60:63], a[120:123], v[20:23]
ds_read_b64_tr_b16 v[48:49], v5 offset:45056
s_waitcnt lgkmcnt(9)
v_mfma_f32_16x16x32_bf16 v[20:23], v[64:67], a[128:131], v[20:23]
ds_read_b64_tr_b16 v[50:51], v5 offset:47104
s_waitcnt lgkmcnt(8)
v_mfma_f32_16x16x32_bf16 v[20:23], v[68:71], a[136:139], v[20:23]
ds_read_b64_tr_b16 v[52:53], v5 offset:49152
v_mfma_f32_16x16x32_bf16 v[24:27], v[60:63], a[124:127], v[24:27]
ds_read_b64_tr_b16 v[54:55], v5 offset:51200
v_mfma_f32_16x16x32_bf16 v[24:27], v[64:67], a[132:135], v[24:27]
ds_read_b64_tr_b16 v[56:57], v5 offset:53248
v_mfma_f32_16x16x32_bf16 v[24:27], v[68:71], a[140:143], v[24:27]
ds_read_b64_tr_b16 v[58:59], v5 offset:55296
s_barrier
s_waitcnt lgkmcnt(10)
v_mfma_f32_16x16x32_bf16 v[28:31], v[36:39], a[0:3], 0
ds_read_b64_tr_b16 v[60:61], v6 offset:49152
s_waitcnt vmcnt(4)
v_lshlrev_b32 v72, 16, v104
v_and_b32 v73, s42, v104
v_lshlrev_b32 v74, 16, v105
s_waitcnt lgkmcnt(9)
v_mfma_f32_16x16x32_bf16 v[28:31], v[40:43], a[8:11], v[28:31]
ds_read_b64_tr_b16 v[62:63], v6 offset:51200
v_and_b32 v75, s42, v105
v_lshlrev_b32 v76, 16, v106
s_waitcnt lgkmcnt(8)
v_mfma_f32_16x16x32_bf16 v[28:31], v[44:47], a[16:19], v[28:31]
ds_read_b64_tr_b16 v[64:65], v6 offset:53248
v_and_b32 v77, s42, v106
v_lshlrev_b32 v78, 16, v107
v_and_b32 v79, s42, v107
v_mfma_f32_16x16x32_bf16 v[32:35], v[36:39], a[4:7], 0
ds_read_b64_tr_b16 v[66:67], v6 offset:55296
v_cvt_pk_bf16_f32 v80, v20, v21
v_cvt_pk_bf16_f32 v81, v22, v23
v_cvt_pk_bf16_f32 v82, v24, v25
v_lshlrev_b32 v17, 16, v11
v_and_b32 v18, s42, v11
v_mfma_f32_16x16x32_bf16 v[32:35], v[40:43], a[12:15], v[32:35]
ds_read_b64_tr_b16 v[68:69], v5 offset:16384
v_cvt_pk_bf16_f32 v83, v26, v27
v_min_u32 v80, -2, v80
v_min_u32 v81, -2, v81
v_permlane32_swap_b32 v72, v76
v_permlane32_swap_b32 v73, v77
v_mfma_f32_16x16x32_bf16 v[32:35], v[44:47], a[20:23], v[32:35]
ds_read_b64_tr_b16 v[70:71], v5 offset:18432
v_min_u32 v82, -2, v82
v_min_u32 v83, -2, v83
s_add_u32 s81, s81, 8192
s_and_b32 s81, s81, 65535
buffer_store_dwordx4 v[80:83], v16, s[16:19], s81 offen sc1
v_permlane32_swap_b32 v74, v78
v_permlane32_swap_b32 v75, v79
v_add_f32 v72, v72, v76
s_waitcnt lgkmcnt(10)
v_mfma_f32_16x16x32_bf16 v[28:31], v[48:51], a[24:27], v[28:31]
ds_read_b64_tr_b16 v[36:37], v5 offset:20480
v_add_f32 v73, v73, v77
v_add_f32 v74, v74, v78
s_waitcnt lgkmcnt(9)
v_mfma_f32_16x16x32_bf16 v[28:31], v[52:55], a[32:35], v[28:31]
ds_read_b64_tr_b16 v[38:39], v5 offset:22528
v_add_f32 v75, v75, v79
s_nop 1
v_permlane16_swap_b32 v72, v74
s_waitcnt lgkmcnt(8)
v_mfma_f32_16x16x32_bf16 v[28:31], v[56:59], a[40:43], v[28:31]
ds_read_b64_tr_b16 v[40:41], v5 offset:24576
v_permlane16_swap_b32 v73, v75
v_add_f32 v72, v72, v74
v_mfma_f32_16x16x32_bf16 v[32:35], v[48:51], a[28:31], v[32:35]
ds_read_b64_tr_b16 v[42:43], v5 offset:26624
v_add_f32 v73, v73, v75
s_nop 1
v_mfma_f32_16x16x32_bf16 v[32:35], v[52:55], a[36:39], v[32:35]
ds_read_b64_tr_b16 v[44:45], v5 offset:28672
v_add_f32_dpp v72, v72, v72 row_ror:8 row_mask:0xf bank_mask:0xf
v_add_f32_dpp v73, v73, v73 row_ror:8 row_mask:0xf bank_mask:0xf
v_fma_f32 v72, v72, s43, v17
v_mfma_f32_16x16x32_bf16 v[32:35], v[56:59], a[44:47], v[32:35]
ds_read_b64_tr_b16 v[46:47], v5 offset:30720
v_fma_f32 v73, v73, s43, v18
v_cvt_pk_bf16_f32 v19, v72, v73
s_barrier
s_waitcnt lgkmcnt(10)
v_mfma_f32_16x16x32_bf16 v[28:31], v[60:63], a[48:51], v[28:31]
ds_read_b64_tr_b16 v[48:49], v6 offset:57344
buffer_store_dword v19, v4, s[4:7], 0 offen
s_waitcnt vmcnt(5)
v_lshlrev_b32 v72, 16, v84
v_and_b32 v73, s42, v84
s_waitcnt lgkmcnt(9)
v_mfma_f32_16x16x32_bf16 v[28:31], v[64:67], a[56:59], v[28:31]
ds_read_b64_tr_b16 v[50:51], v6 offset:59392
v_lshlrev_b32 v74, 16, v85
v_and_b32 v75, s42, v85
s_waitcnt lgkmcnt(8)
v_mfma_f32_16x16x32_bf16 v[28:31], v[68:71], a[64:67], v[28:31]
ds_read_b64_tr_b16 v[52:53], v6 offset:61440
v_lshlrev_b32 v76, 16, v86
v_and_b32 v77, s42, v86
buffer_load_dword v10, v12, s[16:19], 0 offen sc1
v_mfma_f32_16x16x32_bf16 v[32:35], v[60:63], a[52:55], v[32:35]
ds_read_b64_tr_b16 v[54:55], v6 offset:63488
v_lshlrev_b32 v78, 16, v87
v_and_b32 v79, s42, v87
s_waitcnt vmcnt(5)
v_lshlrev_b32 v17, 16, v88
v_mfma_f32_16x16x32_bf16 v[32:35], v[64:67], a[60:63], v[32:35]
ds_read_b64_tr_b16 v[56:57], v5 offset:57344
v_and_b32 v18, s42, v88
v_add_f32 v72, v72, v17
v_mfma_f32_16x16x32_bf16 v[32:35], v[68:71], a[68:71], v[32:35]
ds_read_b64_tr_b16 v[58:59], v5 offset:59392
v_add_f32 v73, v73, v18
v_lshlrev_b32 v17, 16, v89
s_waitcnt lgkmcnt(10)
v_mfma_f32_16x16x32_bf16 v[28:31], v[36:39], a[72:75], v[28:31]
ds_read_b64_tr_b16 v[60:61], v5 offset:61440
v_and_b32 v18, s42, v89
v_add_f32 v74, v74, v17
v_add_f32 v75, v75, v18
s_waitcnt lgkmcnt(9)
v_mfma_f32_16x16x32_bf16 v[28:31], v[40:43], a[80:83], v[28:31]
ds_read_b64_tr_b16 v[62:63], v5 offset:63488
v_lshlrev_b32 v17, 16, v90
v_and_b32 v18, s42, v90
s_waitcnt lgkmcnt(8)
v_mfma_f32_16x16x32_bf16 v[28:31], v[44:47], a[88:91], v[28:31]
ds_read_b64_tr_b16 v[64:65], v6 offset:0
v_add_f32 v76, v76, v17
v_add_f32 v77, v77, v18
v_lshlrev_b32 v17, 16, v91
v_mfma_f32_16x16x32_bf16 v[32:35], v[36:39], a[76:79], v[32:35]
ds_read_b64_tr_b16 v[66:67], v6 offset:2048
v_and_b32 v18, s42, v91
v_add_f32 v78, v78, v17
v_mfma_f32_16x16x32_bf16 v[32:35], v[40:43], a[84:87], v[32:35]
ds_read_b64_tr_b16 v[68:69], v6 offset:4096
v_add_f32 v79, v79, v18
s_waitcnt vmcnt(4)
v_lshlrev_b32 v17, 16, v92
v_mfma_f32_16x16x32_bf16 v[32:35], v[44:47], a[92:95], v[32:35]
ds_read_b64_tr_b16 v[70:71], v6 offset:6144
v_and_b32 v18, s42, v92
v_add_f32 v72, v72, v17
v_add_f32 v73, v73, v18
s_barrier
s_waitcnt lgkmcnt(10)
v_mfma_f32_16x16x32_bf16 v[28:31], v[48:51], a[96:99], v[28:31]
v_lshlrev_b32 v17, 16, v93
v_and_b32 v18, s42, v93
s_waitcnt lgkmcnt(8)
v_mfma_f32_16x16x32_bf16 v[28:31], v[52:55], a[104:107], v[28:31]
v_add_f32 v74, v74, v17
v_add_f32 v75, v75, v18
v_lshlrev_b32 v17, 16, v94
s_waitcnt lgkmcnt(6)
v_mfma_f32_16x16x32_bf16 v[28:31], v[56:59], a[112:115], v[28:31]
v_and_b32 v18, s42, v94
v_add_f32 v76, v76, v17
v_mfma_f32_16x16x32_bf16 v[32:35], v[48:51], a[100:103], v[32:35]
v_add_f32 v77, v77, v18
v_lshlrev_b32 v17, 16, v95
v_mfma_f32_16x16x32_bf16 v[32:35], v[52:55], a[108:111], v[32:35]
v_and_b32 v18, s42, v95
v_add_f32 v78, v78, v17
v_add_f32 v79, v79, v18
s_waitcnt vmcnt(0)
s_mov_b32 s39, 0x10000
standalone__mixer_channel_mlp__prompt_kernel_pl:
v_cmp_ne_u32 vcc, v13, v10
s_and_b64 s[32:33], vcc, s[30:31]
s_cbranch_scc0 standalone__mixer_channel_mlp__prompt_kernel_pl_ok
s_sub_u32 s39, s39, 1
s_cbranch_scc1 standalone__mixer_channel_mlp__prompt_kernel_pl_ok
buffer_load_dword v10, v12, s[16:19], 0 offen sc1
s_waitcnt vmcnt(0)
s_branch standalone__mixer_channel_mlp__prompt_kernel_pl
standalone__mixer_channel_mlp__prompt_kernel_pl_ok:
s_mov_b32 vcc_lo, s27
s_mov_b32 vcc_hi, 0
s_sub_u32 s36, s25, 5
s_and_b32 s36, s36, 7
s_mul_i32 s36, s36, 73728
buffer_load_dwordx4 v[108:111], v2, s[16:19], s36 offen sc1
s_sub_u32 s36, s25, 6
s_and_b32 s36, s36, 7
s_mul_i32 s36, s36, 73728
buffer_load_dwordx4 v[24:27], v2, s[16:19], s36 offen sc1
s_sub_u32 s36, s25, 7
s_and_b32 s36, s36, 7
s_mul_i32 s36, s36, 73728
buffer_load_dwordx4 v[20:23], v2, s[16:19], s36 offen sc1
v_mfma_f32_16x16x32_bf16 v[32:35], v[56:59], a[116:119], v[32:35]
v_lshlrev_b32 v17, 16, v96
v_and_b32 v18, s42, v96
s_waitcnt lgkmcnt(4)
v_mfma_f32_16x16x32_bf16 v[28:31], v[60:63], a[120:123], v[28:31]
v_add_f32 v72, v72, v17
v_add_f32 v73, v73, v18
v_lshlrev_b32 v17, 16, v97
s_waitcnt lgkmcnt(2)
v_mfma_f32_16x16x32_bf16 v[28:31], v[64:67], a[128:131], v[28:31]
v_and_b32 v18, s42, v97
v_add_f32 v74, v74, v17
s_waitcnt lgkmcnt(0)
v_mfma_f32_16x16x32_bf16 v[28:31], v[68:71], a[136:139], v[28:31]
v_add_f32 v75, v75, v18
v_lshlrev_b32 v17, 16, v98
v_mfma_f32_16x16x32_bf16 v[32:35], v[60:63], a[124:127], v[32:35]
v_and_b32 v18, s42, v98
v_add_f32 v76, v76, v17
v_add_f32 v77, v77, v18
v_mfma_f32_16x16x32_bf16 v[32:35], v[64:67], a[132:135], v[32:35]
v_lshlrev_b32 v17, 16, v99
v_and_b32 v18, s42, v99
v_mfma_f32_16x16x32_bf16 v[32:35], v[68:71], a[140:143], v[32:35]
v_add_f32 v78, v78, v17
v_add_f32 v79, v79, v18
s_nop 3
v_lshlrev_b32 v80, 16, v0
v_and_b32 v81, s42, v0
v_lshlrev_b32 v82, 16, v1
v_and_b32 v83, s42, v1
v_add_f32 v72, v72, v28
v_add_f32 v73, v73, v29
v_add_f32 v74, v74, v30
v_add_f32 v75, v75, v31
v_add_f32 v76, v76, v32
v_add_f32 v77, v77, v33
v_add_f32 v78, v78, v34
v_add_f32 v79, v79, v35
s_waitcnt vmcnt(2)
v_lshlrev_b32 v17, 16, v108
v_and_b32 v18, s42, v108
v_add_f32 v72, v72, v17
v_add_f32 v73, v73, v18
v_lshlrev_b32 v17, 16, v109
v_and_b32 v18, s42, v109
v_add_f32 v74, v74, v17
v_add_f32 v75, v75, v18
v_lshlrev_b32 v17, 16, v110
v_and_b32 v18, s42, v110
v_add_f32 v76, v76, v17
v_add_f32 v77, v77, v18
v_lshlrev_b32 v17, 16, v111
v_and_b32 v18, s42, v111
v_add_f32 v78, v78, v17
v_add_f32 v79, v79, v18
s_waitcnt vmcnt(1)
v_lshlrev_b32 v17, 16, v24
v_and_b32 v18, s42, v24
v_add_f32 v72, v72, v17
v_add_f32 v73, v73, v18
v_lshlrev_b32 v17, 16, v25
v_and_b32 v18, s42, v25
v_add_f32 v74, v74, v17
v_add_f32 v75, v75, v18
v_lshlrev_b32 v17, 16, v26
v_and_b32 v18, s42, v26
v_add_f32 v76, v76, v17
v_add_f32 v77, v77, v18
v_lshlrev_b32 v17, 16, v27
v_and_b32 v18, s42, v27
v_add_f32 v78, v78, v17
v_add_f32 v79, v79, v18
s_waitcnt vmcnt(0)
s_mov_b32 s39, 0x10000
standalone__mixer_channel_mlp__prompt_kernel_sv7:
v_max_u32 v17, v20, v21
v_max3_u32 v17, v17, v22, v23
v_cmp_eq_u32 vcc, -1, v17
s_and_b64 s[32:33], vcc, exec
s_cbranch_scc0 standalone__mixer_channel_mlp__prompt_kernel_sv7_ok
s_sub_u32 s39, s39, 1
s_cbranch_scc1 standalone__mixer_channel_mlp__prompt_kernel_sv7_ok
s_sub_u32 s36, s25, 7
s_and_b32 s36, s36, 7
s_mul_i32 s36, s36, 73728
buffer_load_dwordx4 v[20:23], v2, s[16:19], s36 offen sc1
s_waitcnt vmcnt(0)
s_branch standalone__mixer_channel_mlp__prompt_kernel_sv7
standalone__mixer_channel_mlp__prompt_kernel_sv7_ok:
s_mov_b32 vcc_lo, s27
s_mov_b32 vcc_hi, 0
v_lshlrev_b32 v17, 16, v20
v_and_b32 v18, s42, v20
v_add_f32 v72, v72, v17
v_add_f32 v73, v73, v18
v_lshlrev_b32 v17, 16, v21
v_and_b32 v18, s42, v21
v_add_f32 v74, v74, v17
v_add_f32 v75, v75, v18
v_lshlrev_b32 v17, 16, v22
v_and_b32 v18, s42, v22
v_add_f32 v76, v76, v17
v_add_f32 v77, v77, v18
v_lshlrev_b32 v17, 16, v23
v_and_b32 v18, s42, v23
v_add_f32 v78, v78, v17
v_add_f32 v79, v79, v18
v_fma_f32 v72, v72, s43, v80
v_fma_f32 v73, v73, s43, v81
v_fma_f32 v74, v74, s43, v82
v_fma_f32 v75, v75, s43, v83
v_fma_f32 v76, v76, s43, v80
v_fma_f32 v77, v77, s43, v81
v_fma_f32 v78, v78, s43, v82
v_fma_f32 v79, v79, s43, v83
v_cvt_pk_bf16_f32 v108, v72, v73
v_cvt_pk_bf16_f32 v109, v74, v75
v_cvt_pk_bf16_f32 v110, v76, v77
v_cvt_pk_bf16_f32 v111, v78, v79
buffer_store_dwordx2 v[108:109], v8, s[4:7], 0 offen
s_mov_b32 s36, 18432
buffer_store_dwordx2 v[110:111], v8, s[4:7], s36 offen
standalone__mixer_channel_mlp__prompt_kernel_end:
s_endpgm
.section .rodata,"a"
.p2align 6
.amdhsa_kernel standalone__mixer_channel_mlp__prompt_kernel
  .amdhsa_next_free_vgpr 256
  .amdhsa_next_free_sgpr 102
  .amdhsa_accum_offset 112
  .amdhsa_group_segment_fixed_size 0
  .amdhsa_kernarg_size 64
  .amdhsa_user_sgpr_count 2
  .amdhsa_user_sgpr_kernarg_segment_ptr 1
  .amdhsa_system_sgpr_workgroup_id_x 1
.end_amdhsa_kernel
```
